```python
import torch

def _softmax(x, axis=-1):
    return torch.softmax(x, dim=axis)
def _gelu(x):
    return torch.nn.functional.gelu(x, approximate="tanh")
def _silu(x):
    return torch.nn.functional.silu(x)
def _sigmoid(x):
    return torch.sigmoid(x)
def _layernorm(x, axis=-1, eps=1e-5):
    m = x.mean(dim=axis, keepdim=True)
    v = x.var(dim=axis, keepdim=True, unbiased=False)
    return (x - m) / torch.sqrt(v + eps)
def _scatter_add(tgt, idx, src, axis=0):
    return tgt.clone().index_add_(axis, idx, src)
def _segment_sum(src, seg, n):
    out = torch.zeros((n,) + src.shape[1:], dtype=src.dtype)
    return out.index_add_(0, seg, src)
def _pad(x, pw):
    flat = tuple(v for pair in reversed(pw) for v in pair)
    return torch.nn.functional.pad(x, flat)

kernel_name = 'recurrent_scan__spectral_fnet__dense_activation_squared_relu__prompt'

def setup_inputs():

    _w = (lambda a: (lambda t: t.to(torch.bfloat16) if t.is_floating_point() else t)(torch.as_tensor(a)))
    def _A_setup():
        B, S, D = 1, 2048, 512
        ns = torch.arange(S)[:, None] * torch.arange(S)[None, :]
        nd = torch.arange(D)[:, None] * torch.arange(D)[None, :]
        Ws_re = torch.cos(-2.0 * torch.pi * ns / S).to(float)
        Ws_im = torch.sin(-2.0 * torch.pi * ns / S).to(float)
        Wd_re = torch.cos(-2.0 * torch.pi * nd / D).to(float)
        Wd_im = torch.sin(-2.0 * torch.pi * nd / D).to(float)
        return {
            "x": _w((lambda *s: torch.randn(*s, dtype=torch.bfloat16) * 0.05)(B, S, D)),
            "dft_seq_re": _w(Ws_re),
            "dft_seq_im": _w(Ws_im),
            "dft_hid_re": _w(Wd_re),
            "dft_hid_im": _w(Wd_im),
        }
    _A_in = _A_setup()

    def _B_setup():
        B, S, D, F = 1, 2048, 512, 1792
        return {
            "x": _w((lambda *s: torch.randn(*s, dtype=torch.bfloat16) * 0.05)(B, S, D)),
            "w1": _w((lambda *s: torch.randn(*s, dtype=torch.bfloat16) * 0.05)(D, F)),
            "b1": _w((lambda *s: torch.randn(*s, dtype=torch.bfloat16) * 0.4)(F)),
            "w2": _w((lambda *s: torch.randn(*s, dtype=torch.bfloat16) * 0.05)(F, D)),
            "b2": _w((lambda *s: torch.randn(*s, dtype=torch.bfloat16) * 0.8)(D)),
        }
    _B_in = _B_setup()

    return {
        "A_x": _A_in["x"],
        "A_dft_seq_re": _A_in["dft_seq_re"],
        "A_dft_seq_im": _A_in["dft_seq_im"],
        "A_dft_hid_re": _A_in["dft_hid_re"],
        "A_dft_hid_im": _A_in["dft_hid_im"],
        "B_x": _B_in["x"],
        "B_w1": _B_in["w1"],
        "B_b1": _B_in["b1"],
        "B_w2": _B_in["w2"],
        "B_b2": _B_in["b2"],
    }

def reference(A_x, A_dft_seq_re, A_dft_seq_im, A_dft_hid_re, A_dft_hid_im, B_x, B_w1, B_b1, B_w2, B_b2):
    def _A_ref(x, dft_seq_re, dft_seq_im, dft_hid_re, dft_hid_im):
        a = torch.einsum("bsd,ed->bse", x, dft_hid_re)
        b = torch.einsum("bsd,ed->bse", x, dft_hid_im)
        y = torch.einsum("ts,bse->bte", dft_seq_re, a) - torch.einsum("ts,bse->bte", dft_seq_im, b)
        return y

    def _B_ref(x, w1, b1, w2, b2):
        h = torch.einsum("bsd,df->bsf", x, w1) + b1
        zero = torch.zeros_like(h)
        r = torch.where(h > zero, h, zero)
        h = r * r
        out = torch.einsum("bsf,fd->bsd", h, w2) + b2
        return out

    x = A_x
    xn = _layernorm(x, axis=-1)
    s = _A_ref(xn, A_dft_seq_re, A_dft_seq_im, A_dft_hid_re, A_dft_hid_im)
    g = _silu(_B_ref(xn, B_w1, B_b1, B_w2, B_b2))
    return x + s * g
```

```asm
; @launch grid=(256,1,1) block=(512,1,1) lds=163840
.amdgcn_target "amdgcn-amd-amdhsa--gfx950"
.text
.globl recurrent_scan__spectral_fnet__dense_activation_squared_relu__prompt_kernel
.p2align 8
.type recurrent_scan__spectral_fnet__dense_activation_squared_relu__prompt_kernel,@function
recurrent_scan__spectral_fnet__dense_activation_squared_relu__prompt_kernel:
  s_cmp_ge_u32 s2, 256
  s_cbranch_scc1 k_end
  s_load_dwordx16 s[16:31], s[0:1], 0
  s_load_dwordx8 s[32:39], s[0:1], 64
  s_load_dwordx2 s[40:41], s[0:1], 96
  v_and_b32 v1, 63, v0
  v_lshrrev_b32 v6, 6, v0
  v_lshlrev_b32 v2, 4, v1
  v_readfirstlane_b32 s3, v6
  s_getpc_b64 s[42:43]
k_pc:
  s_sub_u32 s42, s42, k_pc-recurrent_scan__spectral_fnet__dense_activation_squared_relu__prompt_kernel
  s_subb_u32 s43, s43, 0
  v_lshlrev_b32 v7, 7, v0
  v_min_u32 v7, k_end-recurrent_scan__spectral_fnet__dense_activation_squared_relu__prompt_kernel-4, v7
  global_load_dword v255, v7, s[42:43]
  s_and_b32 s10, s2, 7
  s_lshr_b32 s77, s2, 3
  s_and_b32 s4, s77, 7
  s_and_b32 s12, s10, 1
  s_lshl_b32 s12, s12, 3
  s_or_b32 s4, s4, s12
  s_lshr_b32 s8, s77, 3
  s_lshr_b32 s6, s8, 1
  s_and_b32 s11, s8, 1
  s_and_b32 s5, s10, 6
  s_or_b32 s5, s5, s11
  s_lshr_b32 s7, s10, 1
  s_lshl_b32 s9, s4, 2
  s_or_b32 s9, s9, s8
  v_and_b32 v3, 31, v1
  v_lshrrev_b32 v4, 5, v1
  v_bfe_u32 v6, v1, 1, 3
  v_xor_b32 v6, v6, v4
  v_lshlrev_b32 v5, 7, v3
  v_lshl_add_u32 v5, v6, 4, v5
  s_cmp_ge_u32 s3, 4
  s_cbranch_scc1 k_helper
  s_waitcnt lgkmcnt(0)
  s_setprio 3
  s_memrealtime s[26:27]
  s_mov_b32 s44, s16
  s_and_b32 s45, s17, 0xffff
  s_mov_b32 s46, 0x200000
  s_mov_b32 s47, 0x00020000
  s_lshl_b32 s10, s7, 2
  s_add_u32 s10, s10, s8
  s_lshl_b32 s10, s10, 2
  s_add_u32 s10, s10, s3
  s_lshl_b32 s10, s10, 1
  s_lshl_b32 s11, s4, 7
  s_add_u32 s76, s10, s11
  s_lshl_b32 s10, s76, 10
  v_lshlrev_b32 v31, 4, v3
  v_lshl_add_u32 v31, v4, 10, v31
  buffer_load_dwordx4 v[240:243], v31, s[44:47], s10 offen
  buffer_load_dwordx4 v[244:247], v31, s[44:47], s10 offen offset:512
  s_mov_b32 s52, s40
  s_and_b32 s53, s41, 0xffff
  s_mov_b32 s54, 0x2000000
  s_mov_b32 s55, 0x00020000
  s_mov_b32 s64, s38
  s_and_b32 s65, s39, 0xffff
  s_mov_b32 s66, 0x100
  s_mov_b32 s67, 0x00020000
  v_mov_b32 v251, 0
  s_waitcnt lgkmcnt(0)
  s_and_b32 s14, s26, 0x3fffffff
  s_or_b32 s14, s14, 0x40000000
  v_mov_b32 v250, s14
  v_mov_b32 v252, s14
  s_lshl_b32 s14, s9, 9
  s_lshl_b32 s10, s7, 2
  s_add_u32 s14, s14, s10
  s_add_u32 s14, s14, 0xf00000
  s_lshl_b32 s10, s3, 7
  s_add_u32 s79, s14, s10
  s_cmp_eq_u32 s6, 0
  s_cbranch_scc0 c_h
  s_cmp_lt_u32 s5, 4
  s_cselect_b32 s48, s22, s24
  s_cselect_b32 s49, s23, s25
  s_and_b32 s49, s49, 0xffff
  s_mov_b32 s50, 0x80000
  s_mov_b32 s51, 0x00020000
  s_lshl_b32 s10, s5, 4
  s_add_u32 s10, s10, s4
  s_lshl_b32 s10, s10, 2
  s_add_u32 s10, s10, s3
  s_lshl_b32 s75, s10, 1
  s_and_b32 s10, s75, 511
  s_lshl_b32 s10, s10, 10
  buffer_load_dwordx4 v[160:163], v31, s[48:51], s10 offen
  buffer_load_dwordx4 v[164:167], v31, s[48:51], s10 offen offset:512
  s_cmp_eq_u32 s3, 0
  s_cbranch_scc0 ca_notag
  s_mov_b64 exec, 1
  buffer_atomic_cmpswap v[250:251], v251, s[64:67], 0 offen sc0 sc1
  s_mov_b64 exec, -1
ca_notag:
  s_mov_b32 s56, s32
  s_and_b32 s57, s33, 0xffff
  s_mov_b32 s58, 0x1c0000
  s_mov_b32 s59, 0x00020000
  s_lshl_b32 s10, s4, 3
  s_add_u32 s10, s10, s5
  s_min_u32 s10, s10, 111
  s_mul_i32 s11, s10, 2341
  s_lshr_b32 s11, s11, 16
  s_mul_i32 s12, s11, 28
  s_sub_u32 s12, s10, s12
  s_lshl_b32 s74, s10, 14
  s_add_u32 s74, s74, 0xc00000
  s_lshl_b32 s12, s12, 16
  s_lshl_b32 s11, s11, 8
  s_add_u32 s12, s12, s11
  s_lshl_b32 s11, s3, 14
  s_add_u32 s12, s12, s11
  s_mov_b32 s72, s12
  s_lshl_b32 s11, s3, 10
  s_add_u32 s74, s74, s11
  s_lshr_b32 s10, s3, 1
  s_and_b32 s11, s3, 1
  s_lshl_b32 s10, s10, 13
  s_lshl_b32 s11, s11, 13
  s_add_u32 s11, s11, 16384
  v_xor_b32 v6, 0, v5
  v_add_u32 v16, s10, v6
  v_add_u32 v20, s11, v6
  v_xor_b32 v6, 32, v5
  v_add_u32 v17, s10, v6
  v_add_u32 v21, s11, v6
  v_xor_b32 v6, 64, v5
  v_add_u32 v18, s10, v6
  v_add_u32 v22, s11, v6
  v_xor_b32 v6, 96, v5
  v_add_u32 v19, s10, v6
  v_add_u32 v23, s11, v6
  v_mov_b32 v96, 0
  v_mov_b32 v97, 0
  v_mov_b32 v98, 0
  v_mov_b32 v99, 0
  v_mov_b32 v100, 0
  v_mov_b32 v101, 0
  v_mov_b32 v102, 0
  v_mov_b32 v103, 0
  v_mov_b32 v104, 0
  v_mov_b32 v105, 0
  v_mov_b32 v106, 0
  v_mov_b32 v107, 0
  v_mov_b32 v108, 0
  v_mov_b32 v109, 0
  v_mov_b32 v110, 0
  v_mov_b32 v111, 0
  v_mov_b32 v112, 0
  v_mov_b32 v113, 0
  v_mov_b32 v114, 0
  v_mov_b32 v115, 0
  v_mov_b32 v116, 0
  v_mov_b32 v117, 0
  v_mov_b32 v118, 0
  v_mov_b32 v119, 0
  v_mov_b32 v120, 0
  v_mov_b32 v121, 0
  v_mov_b32 v122, 0
  v_mov_b32 v123, 0
  v_mov_b32 v124, 0
  v_mov_b32 v125, 0
  v_mov_b32 v126, 0
  v_mov_b32 v127, 0
  v_mov_b32 v128, 0
  v_mov_b32 v129, 0
  v_mov_b32 v130, 0
  v_mov_b32 v131, 0
  v_mov_b32 v132, 0
  v_mov_b32 v133, 0
  v_mov_b32 v134, 0
  v_mov_b32 v135, 0
  v_mov_b32 v136, 0
  v_mov_b32 v137, 0
  v_mov_b32 v138, 0
  v_mov_b32 v139, 0
  v_mov_b32 v140, 0
  v_mov_b32 v141, 0
  v_mov_b32 v142, 0
  v_mov_b32 v143, 0
  v_mov_b32 v144, 0
  v_mov_b32 v145, 0
  v_mov_b32 v146, 0
  v_mov_b32 v147, 0
  v_mov_b32 v148, 0
  v_mov_b32 v149, 0
  v_mov_b32 v150, 0
  v_mov_b32 v151, 0
  v_mov_b32 v152, 0
  v_mov_b32 v153, 0
  v_mov_b32 v154, 0
  v_mov_b32 v155, 0
  v_mov_b32 v156, 0
  v_mov_b32 v157, 0
  v_mov_b32 v158, 0
  v_mov_b32 v159, 0
  v_mov_b32 v64, 0
  v_mov_b32 v65, 0
  v_mov_b32 v66, 0
  v_mov_b32 v67, 0
  v_mov_b32 v68, 0
  v_mov_b32 v69, 0
  v_mov_b32 v70, 0
  v_mov_b32 v71, 0
  v_mov_b32 v72, 0
  v_mov_b32 v73, 0
  v_mov_b32 v74, 0
  v_mov_b32 v75, 0
  v_mov_b32 v76, 0
  v_mov_b32 v77, 0
  v_mov_b32 v78, 0
  v_mov_b32 v79, 0
  v_mov_b32 v80, 0
  v_mov_b32 v81, 0
  v_mov_b32 v82, 0
  v_mov_b32 v83, 0
  v_mov_b32 v84, 0
  v_mov_b32 v85, 0
  v_mov_b32 v86, 0
  v_mov_b32 v87, 0
  v_mov_b32 v88, 0
  v_mov_b32 v89, 0
  v_mov_b32 v90, 0
  v_mov_b32 v91, 0
  v_mov_b32 v92, 0
  v_mov_b32 v93, 0
  v_mov_b32 v94, 0
  v_mov_b32 v95, 0
  s_waitcnt vmcnt(1)
  s_cmp_eq_u32 s3, 0
  s_cbranch_scc1 ca_sw
  s_waitcnt vmcnt(0)
ca_sw:
  v_mov_b32 v174, 0x3f803f80
  v_lshlrev_b32 v175, 4, v4
  v_dot2_f32_bf16 v168, v240, v174, 0
  v_dot2_f32_bf16 v170, v240, v240, 0
  v_dot2_f32_bf16 v172, v160, v174, 0
  v_dot2_f32_bf16 v169, v241, v174, 0
  v_dot2_f32_bf16 v171, v241, v241, 0
  v_dot2_f32_bf16 v173, v161, v174, 0
  v_dot2_f32_bf16 v168, v242, v174, v168
  v_dot2_f32_bf16 v170, v242, v242, v170
  v_dot2_f32_bf16 v172, v162, v174, v172
  v_dot2_f32_bf16 v169, v243, v174, v169
  v_dot2_f32_bf16 v171, v243, v243, v171
  v_dot2_f32_bf16 v173, v163, v174, v173
  v_dot2_f32_bf16 v168, v244, v174, v168
  v_dot2_f32_bf16 v170, v244, v244, v170
  v_dot2_f32_bf16 v172, v164, v174, v172
  v_dot2_f32_bf16 v169, v245, v174, v169
  v_dot2_f32_bf16 v171, v245, v245, v171
  v_dot2_f32_bf16 v173, v165, v174, v173
  v_dot2_f32_bf16 v168, v246, v174, v168
  v_dot2_f32_bf16 v170, v246, v246, v170
  v_dot2_f32_bf16 v172, v166, v174, v172
  v_dot2_f32_bf16 v169, v247, v174, v169
  v_dot2_f32_bf16 v171, v247, v247, v171
  v_dot2_f32_bf16 v173, v167, v174, v173
  s_nop 2
  v_add_f32 v168, v168, v169
  v_add_f32 v170, v170, v171
  v_add_f32 v172, v172, v173
  v_add_f32_dpp v168, v168, v168 row_shr:1 row_mask:0xf bank_mask:0xf bound_ctrl:0
  v_add_f32_dpp v170, v170, v170 row_shr:1 row_mask:0xf bank_mask:0xf bound_ctrl:0
  v_add_f32_dpp v172, v172, v172 row_shr:1 row_mask:0xf bank_mask:0xf bound_ctrl:0
  v_add_f32_dpp v168, v168, v168 row_shr:2 row_mask:0xf bank_mask:0xf bound_ctrl:0
  v_add_f32_dpp v170, v170, v170 row_shr:2 row_mask:0xf bank_mask:0xf bound_ctrl:0
  v_add_f32_dpp v172, v172, v172 row_shr:2 row_mask:0xf bank_mask:0xf bound_ctrl:0
  v_add_f32_dpp v168, v168, v168 row_shr:4 row_mask:0xf bank_mask:0xf bound_ctrl:0
  v_add_f32_dpp v170, v170, v170 row_shr:4 row_mask:0xf bank_mask:0xf bound_ctrl:0
  v_add_f32_dpp v172, v172, v172 row_shr:4 row_mask:0xf bank_mask:0xf bound_ctrl:0
  v_add_f32_dpp v168, v168, v168 row_shr:8 row_mask:0xf bank_mask:0xf bound_ctrl:0
  v_add_f32_dpp v170, v170, v170 row_shr:8 row_mask:0xf bank_mask:0xf bound_ctrl:0
  v_add_f32_dpp v172, v172, v172 row_shr:8 row_mask:0xf bank_mask:0xf bound_ctrl:0
  v_add_f32_dpp v168, v168, v168 row_bcast:15 row_mask:0xa bank_mask:0xf
  v_add_f32_dpp v170, v170, v170 row_bcast:15 row_mask:0xa bank_mask:0xf
  v_add_f32_dpp v172, v172, v172 row_bcast:15 row_mask:0xa bank_mask:0xf
  v_mul_f32 v168, 0x3b000000, v168
  v_mul_f32 v170, 0x3b000000, v170
  v_fma_f32 v170, -v168, v168, v170
  v_max_f32 v170, 0, v170
  v_cvt_pk_bf16_f32 v169, v170, v170
  v_lshlrev_b32 v170, 16, v169
  v_add_f32 v170, 0x3727c5ac, v170
  v_cvt_pk_bf16_f32 v169, v170, v170
  v_lshlrev_b32 v170, 16, v169
  v_sqrt_f32 v170, v170
  v_xor_b32 v168, 0x80000000, v168
  v_cvt_pk_bf16_f32 v240, v168, v168
  v_cvt_pk_bf16_f32 v241, v168, v170
  v_and_b32 v170, 0xffff0000, v241
  v_rcp_f32 v242, v170
  s_lshl_b32 s10, s76, 4
  s_add_u32 s10, s10, 0xf20000
  v_cvt_pk_bf16_f32 v244, v172, v172
  v_lshlrev_b32 v169, 16, v244
  v_sub_f32 v172, v172, v169
  v_cvt_pk_bf16_f32 v245, v172, v172
  v_lshlrev_b32 v169, 16, v245
  v_sub_f32 v172, v172, v169
  v_cvt_pk_bf16_f32 v246, v172, v172
  v_and_b32 v244, 0xffff, v244
  v_lshl_or_b32 v244, v245, 16, v244
  v_and_b32 v245, 0xffff, v246
  v_mov_b32 v246, 0
  s_lshl_b32 s11, s75, 4
  s_add_u32 s11, s11, 0xf28000
  s_mov_b32 s26, s10
  s_mov_b32 s27, s11
  s_setprio 0
  s_mov_b32 s70, 0
  s_mov_b32 s69, 8
  s_mov_b32 s71, 1
  s_mov_b32 s43, 0
  s_mov_b32 s78, 0x20000
  s_mov_b32 s68, 0
sl_top:
  s_cmp_eq_u32 s68, s71
  s_cbranch_scc1 sl_hook
sl_ret:
  s_barrier
  v_mfma_f32_32x32x16_bf16 v[96:111], v[72:75], v[64:67], v[96:111]
  ds_read_b128 v[32:35], v16 offset:0
  ds_read_b128 v[40:43], v20 offset:0
  v_mfma_f32_32x32x16_bf16 v[112:127], v[76:79], v[64:67], v[112:127]
  ds_read_b128 v[36:39], v16 offset:4096
  ds_read_b128 v[44:47], v20 offset:4096
  v_mfma_f32_32x32x16_bf16 v[128:143], v[72:75], v[68:71], v[128:143]
  ds_read_b128 v[48:51], v17 offset:0
  ds_read_b128 v[56:59], v21 offset:0
  v_mfma_f32_32x32x16_bf16 v[144:159], v[76:79], v[68:71], v[144:159]
  ds_read_b128 v[52:55], v17 offset:4096
  ds_read_b128 v[60:63], v21 offset:4096
  v_mfma_f32_32x32x16_bf16 v[96:111], v[88:91], v[80:83], v[96:111]
  ds_read_b128 v[64:67], v18 offset:0
  v_mfma_f32_32x32x16_bf16 v[112:127], v[92:95], v[80:83], v[112:127]
  ds_read_b128 v[72:75], v22 offset:0
  v_mfma_f32_32x32x16_bf16 v[128:143], v[88:91], v[84:87], v[128:143]
  ds_read_b128 v[68:71], v18 offset:4096
  v_mfma_f32_32x32x16_bf16 v[144:159], v[92:95], v[84:87], v[144:159]
  ds_read_b128 v[76:79], v22 offset:4096
  s_waitcnt lgkmcnt(8)
  v_mfma_f32_32x32x16_bf16 v[96:111], v[40:43], v[32:35], v[96:111]
  ds_read_b128 v[80:83], v19 offset:0
  v_mfma_f32_32x32x16_bf16 v[112:127], v[44:47], v[32:35], v[112:127]
  ds_read_b128 v[88:91], v23 offset:0
  v_mfma_f32_32x32x16_bf16 v[128:143], v[40:43], v[36:39], v[128:143]
  ds_read_b128 v[84:87], v19 offset:4096
  v_mfma_f32_32x32x16_bf16 v[144:159], v[44:47], v[36:39], v[144:159]
  ds_read_b128 v[92:95], v23 offset:4096
  s_waitcnt lgkmcnt(8)
  v_mfma_f32_32x32x16_bf16 v[96:111], v[56:59], v[48:51], v[96:111]
  s_add_u32 s43, s43, 32768
  s_cmp_eq_u32 s43, s78
  s_cselect_b32 s10, s78, 0
  s_sub_u32 s43, s43, s10
  v_mfma_f32_32x32x16_bf16 v[112:127], v[60:63], v[48:51], v[112:127]
  s_sub_u32 s10, 32768, s10
  v_add_u32 v16, s10, v16
  v_add_u32 v17, s10, v17
  v_add_u32 v18, s10, v18
  v_mfma_f32_32x32x16_bf16 v[128:143], v[56:59], v[52:55], v[128:143]
  v_add_u32 v19, s10, v19
  v_add_u32 v20, s10, v20
  v_add_u32 v21, s10, v21
  v_add_u32 v22, s10, v22
  v_mfma_f32_32x32x16_bf16 v[144:159], v[60:63], v[52:55], v[144:159]
  v_add_u32 v23, s10, v23
  s_add_u32 s68, s68, 1
  s_cmp_lt_u32 s68, s69
  s_waitcnt lgkmcnt(0)
  s_cbranch_scc1 sl_top
  s_cmp_eq_u32 s70, 0
  s_cbranch_scc0 s_exit
  s_lshr_b32 s10, s3, 1
  s_and_b32 s11, s3, 1
  s_lshl_b32 s12, s10, 10
  s_add_u32 s12, s12, 137216
  v_lshl_add_u32 v6, v3, 4, s12
  s_lshl_b32 s12, s11, 10
  s_add_u32 s12, s12, 135168
  v_lshl_add_u32 v7, v3, 4, s12
  v_add_u32 v8, 512, v7
  v_cmp_eq_u32 vcc, 0, v4
  v_mov_b32 v9, 141312
  s_lshl_b32 s12, s11, 8
  s_add_u32 s12, s12, 141888
  v_cndmask_b32 v7, v9, v7, vcc
  v_cndmask_b32 v8, v9, v8, vcc
  v_lshl_add_u32 v9, v4, 4, s12
  s_barrier
  v_mfma_f32_32x32x16_bf16 v[96:111], v[72:75], v[64:67], v[96:111]
  ds_read_b128 v[32:35], v6
  ds_read_b128 v[40:43], v7
  ds_read_b128 v[36:39], v6 offset:512
  ds_read_b128 v[44:47], v8
  v_mfma_f32_32x32x16_bf16 v[112:127], v[76:79], v[64:67], v[112:127]
  ds_read_b128 v[160:163], v9 offset:0
  ds_read_b128 v[164:167], v9 offset:32
  ds_read_b128 v[168:171], v9 offset:64
  ds_read_b128 v[172:175], v9 offset:96
  v_mfma_f32_32x32x16_bf16 v[128:143], v[72:75], v[68:71], v[128:143]
  ds_read_b128 v[176:179], v9 offset:128
  ds_read_b128 v[180:183], v9 offset:160
  ds_read_b128 v[184:187], v9 offset:192
  ds_read_b128 v[188:191], v9 offset:224
  v_mfma_f32_32x32x16_bf16 v[144:159], v[76:79], v[68:71], v[144:159]
  s_lshr_b32 s14, s7, 1
  s_lshl_b32 s14, s14, 1
  s_add_u32 s14, s14, s10
  s_lshl_b32 s14, s14, 7
  v_mfma_f32_32x32x16_bf16 v[96:111], v[88:91], v[80:83], v[96:111]
  s_add_u32 s14, s14, 141376
  v_lshl_add_u32 v10, v3, 2, s14
  ds_read_b32 v248, v10
  s_and_b32 s12, s5, 3
  v_mfma_f32_32x32x16_bf16 v[112:127], v[92:95], v[80:83], v[112:127]
  s_lshl_b32 s12, s12, 6
  s_lshr_b32 s13, s5, 2
  s_lshl_b32 s13, s13, 5
  s_add_u32 s12, s12, s13
  v_mfma_f32_32x32x16_bf16 v[128:143], v[88:91], v[84:87], v[128:143]
  s_lshl_b32 s13, s4, 1
  s_add_u32 s12, s12, s13
  s_add_u32 s12, s12, s11
  s_lshl_b32 s12, s12, 14
  v_mfma_f32_32x32x16_bf16 v[144:159], v[92:95], v[84:87], v[144:159]
  s_lshl_b32 s13, s10, 13
  s_add_u32 s12, s12, s13
  s_add_u32 s13, s12, 4096
  s_waitcnt lgkmcnt(0)
  v_mfma_f32_32x32x16_bf16 v[96:111], v[40:43], v[32:35], v[96:111]
  v_mfma_f32_32x32x16_bf16 v[112:127], v[44:47], v[32:35], v[112:127]
  v_mfma_f32_32x32x16_bf16 v[128:143], v[40:43], v[36:39], v[128:143]
  v_mfma_f32_32x32x16_bf16 v[144:159], v[44:47], v[36:39], v[144:159]
  s_nop 7
  s_nop 4
  v_pk_mul_f32 v[96:97], v[96:97], v[160:161]
  v_pk_mul_f32 v[98:99], v[98:99], v[162:163]
  v_cvt_pk_bf16_f32 v64, v96, v97
  v_cvt_pk_bf16_f32 v65, v98, v99
  v_pk_mul_f32 v[100:101], v[100:101], v[164:165]
  v_pk_mul_f32 v[102:103], v[102:103], v[166:167]
  v_cvt_pk_bf16_f32 v66, v100, v101
  v_cvt_pk_bf16_f32 v67, v102, v103
  s_nop 1
  v_permlane32_swap_b32 v64, v66
  v_permlane32_swap_b32 v65, v67
  buffer_store_dwordx4 v[64:67], v2, s[52:55], s12 offen offset:0 sc1
  v_pk_mul_f32 v[104:105], v[104:105], v[168:169]
  v_pk_mul_f32 v[106:107], v[106:107], v[170:171]
  v_cvt_pk_bf16_f32 v68, v104, v105
  v_cvt_pk_bf16_f32 v69, v106, v107
  v_pk_mul_f32 v[108:109], v[108:109], v[172:173]
  v_pk_mul_f32 v[110:111], v[110:111], v[174:175]
  v_cvt_pk_bf16_f32 v70, v108, v109
  v_cvt_pk_bf16_f32 v71, v110, v111
  s_nop 1
  v_permlane32_swap_b32 v68, v70
  v_permlane32_swap_b32 v69, v71
  buffer_store_dwordx4 v[68:71], v2, s[52:55], s12 offen offset:1024 sc1
  v_pk_mul_f32 v[112:113], v[112:113], v[176:177]
  v_pk_mul_f32 v[114:115], v[114:115], v[178:179]
  v_cvt_pk_bf16_f32 v72, v112, v113
  v_cvt_pk_bf16_f32 v73, v114, v115
  v_pk_mul_f32 v[116:117], v[116:117], v[180:181]
  v_pk_mul_f32 v[118:119], v[118:119], v[182:183]
  v_cvt_pk_bf16_f32 v74, v116, v117
  v_cvt_pk_bf16_f32 v75, v118, v119
  s_nop 1
  v_permlane32_swap_b32 v72, v74
  v_permlane32_swap_b32 v73, v75
  buffer_store_dwordx4 v[72:75], v2, s[52:55], s12 offen offset:2048 sc1
  v_pk_mul_f32 v[120:121], v[120:121], v[184:185]
  v_pk_mul_f32 v[122:123], v[122:123], v[186:187]
  v_cvt_pk_bf16_f32 v76, v120, v121
  v_cvt_pk_bf16_f32 v77, v122, v123
  v_pk_mul_f32 v[124:125], v[124:125], v[188:189]
  v_pk_mul_f32 v[126:127], v[126:127], v[190:191]
  v_cvt_pk_bf16_f32 v78, v124, v125
  v_cvt_pk_bf16_f32 v79, v126, v127
  s_nop 1
  v_permlane32_swap_b32 v76, v78
  v_permlane32_swap_b32 v77, v79
  buffer_store_dwordx4 v[76:79], v2, s[52:55], s12 offen offset:3072 sc1
  v_pk_mul_f32 v[128:129], v[128:129], v[160:161]
  v_pk_mul_f32 v[130:131], v[130:131], v[162:163]
  v_cvt_pk_bf16_f32 v64, v128, v129
  v_cvt_pk_bf16_f32 v65, v130, v131
  v_pk_mul_f32 v[132:133], v[132:133], v[164:165]
  v_pk_mul_f32 v[134:135], v[134:135], v[166:167]
  v_cvt_pk_bf16_f32 v66, v132, v133
  v_cvt_pk_bf16_f32 v67, v134, v135
  s_nop 1
  v_permlane32_swap_b32 v64, v66
  v_permlane32_swap_b32 v65, v67
  buffer_store_dwordx4 v[64:67], v2, s[52:55], s13 offen offset:0 sc1
  v_pk_mul_f32 v[136:137], v[136:137], v[168:169]
  v_pk_mul_f32 v[138:139], v[138:139], v[170:171]
  v_cvt_pk_bf16_f32 v68, v136, v137
  v_cvt_pk_bf16_f32 v69, v138, v139
  v_pk_mul_f32 v[140:141], v[140:141], v[172:173]
  v_pk_mul_f32 v[142:143], v[142:143], v[174:175]
  v_cvt_pk_bf16_f32 v70, v140, v141
  v_cvt_pk_bf16_f32 v71, v142, v143
  s_nop 1
  v_permlane32_swap_b32 v68, v70
  v_permlane32_swap_b32 v69, v71
  buffer_store_dwordx4 v[68:71], v2, s[52:55], s13 offen offset:1024 sc1
  v_pk_mul_f32 v[144:145], v[144:145], v[176:177]
  v_pk_mul_f32 v[146:147], v[146:147], v[178:179]
  v_cvt_pk_bf16_f32 v72, v144, v145
  v_cvt_pk_bf16_f32 v73, v146, v147
  v_pk_mul_f32 v[148:149], v[148:149], v[180:181]
  v_pk_mul_f32 v[150:151], v[150:151], v[182:183]
  v_cvt_pk_bf16_f32 v74, v148, v149
  v_cvt_pk_bf16_f32 v75, v150, v151
  s_nop 1
  v_permlane32_swap_b32 v72, v74
  v_permlane32_swap_b32 v73, v75
  buffer_store_dwordx4 v[72:75], v2, s[52:55], s13 offen offset:2048 sc1
  v_pk_mul_f32 v[152:153], v[152:153], v[184:185]
  v_pk_mul_f32 v[154:155], v[154:155], v[186:187]
  v_cvt_pk_bf16_f32 v76, v152, v153
  v_cvt_pk_bf16_f32 v77, v154, v155
  v_pk_mul_f32 v[156:157], v[156:157], v[188:189]
  v_pk_mul_f32 v[158:159], v[158:159], v[190:191]
  v_cvt_pk_bf16_f32 v78, v156, v157
  v_cvt_pk_bf16_f32 v79, v158, v159
  s_nop 1
  v_permlane32_swap_b32 v76, v78
  v_permlane32_swap_b32 v77, v79
  buffer_store_dwordx4 v[76:79], v2, s[52:55], s13 offen offset:3072 sc1
  s_nop 1
  s_lshr_b32 s10, s3, 1
  s_and_b32 s11, s3, 1
  s_lshl_b32 s10, s10, 13
  s_lshl_b32 s11, s11, 13
  s_add_u32 s11, s11, 16384
  v_add_u32 v20, s11, v2
  s_add_u32 s11, s11, 1024
  v_add_u32 v21, s11, v2
  s_add_u32 s11, s11, 1024
  v_add_u32 v22, s11, v2
  s_add_u32 s11, s11, 1024
  v_add_u32 v23, s11, v2
  v_mov_b32 v96, 0
  v_mov_b32 v97, 0
  v_mov_b32 v98, 0
  v_mov_b32 v99, 0
  v_mov_b32 v100, 0
  v_mov_b32 v101, 0
  v_mov_b32 v102, 0
  v_mov_b32 v103, 0
  v_mov_b32 v104, 0
  v_mov_b32 v105, 0
  v_mov_b32 v106, 0
  v_mov_b32 v107, 0
  v_mov_b32 v108, 0
  v_mov_b32 v109, 0
  v_mov_b32 v110, 0
  v_mov_b32 v111, 0
  v_mov_b32 v112, 0
  v_mov_b32 v113, 0
  v_mov_b32 v114, 0
  v_mov_b32 v115, 0
  v_mov_b32 v116, 0
  v_mov_b32 v117, 0
  v_mov_b32 v118, 0
  v_mov_b32 v119, 0
  v_mov_b32 v120, 0
  v_mov_b32 v121, 0
  v_mov_b32 v122, 0
  v_mov_b32 v123, 0
  v_mov_b32 v124, 0
  v_mov_b32 v125, 0
  v_mov_b32 v126, 0
  v_mov_b32 v127, 0
  v_mov_b32 v128, 0
  v_mov_b32 v129, 0
  v_mov_b32 v130, 0
  v_mov_b32 v131, 0
  v_mov_b32 v132, 0
  v_mov_b32 v133, 0
  v_mov_b32 v134, 0
  v_mov_b32 v135, 0
  v_mov_b32 v136, 0
  v_mov_b32 v137, 0
  v_mov_b32 v138, 0
  v_mov_b32 v139, 0
  v_mov_b32 v140, 0
  v_mov_b32 v141, 0
  v_mov_b32 v142, 0
  v_mov_b32 v143, 0
  v_mov_b32 v144, 0
  v_mov_b32 v145, 0
  v_mov_b32 v146, 0
  v_mov_b32 v147, 0
  v_mov_b32 v148, 0
  v_mov_b32 v149, 0
  v_mov_b32 v150, 0
  v_mov_b32 v151, 0
  v_mov_b32 v152, 0
  v_mov_b32 v153, 0
  v_mov_b32 v154, 0
  v_mov_b32 v155, 0
  v_mov_b32 v156, 0
  v_mov_b32 v157, 0
  v_mov_b32 v158, 0
  v_mov_b32 v159, 0
  v_mov_b32 v64, 0
  v_mov_b32 v65, 0
  v_mov_b32 v66, 0
  v_mov_b32 v67, 0
  v_mov_b32 v68, 0
  v_mov_b32 v69, 0
  v_mov_b32 v70, 0
  v_mov_b32 v71, 0
  v_mov_b32 v72, 0
  v_mov_b32 v73, 0
  v_mov_b32 v74, 0
  v_mov_b32 v75, 0
  v_mov_b32 v76, 0
  v_mov_b32 v77, 0
  v_mov_b32 v78, 0
  v_mov_b32 v79, 0
  v_mov_b32 v80, 0
  v_mov_b32 v81, 0
  v_mov_b32 v82, 0
  v_mov_b32 v83, 0
  v_mov_b32 v84, 0
  v_mov_b32 v85, 0
  v_mov_b32 v86, 0
  v_mov_b32 v87, 0
  v_mov_b32 v88, 0
  v_mov_b32 v89, 0
  v_mov_b32 v90, 0
  v_mov_b32 v91, 0
  v_mov_b32 v92, 0
  v_mov_b32 v93, 0
  v_mov_b32 v94, 0
  v_mov_b32 v95, 0
  v_lshlrev_b32 v7, 1, v1
  s_mov_b32 s71, 2
  s_waitcnt vmcnt(0)
  s_barrier
  buffer_load_ushort v208, v7, s[56:59], s72 offen offset:0
  buffer_load_ushort v224, v7, s[56:59], s72 offen offset:128
  buffer_load_ushort v209, v7, s[56:59], s72 offen offset:1024
  buffer_load_ushort v225, v7, s[56:59], s72 offen offset:1152
  buffer_load_ushort v210, v7, s[56:59], s72 offen offset:2048
  buffer_load_ushort v226, v7, s[56:59], s72 offen offset:2176
  buffer_load_ushort v211, v7, s[56:59], s72 offen offset:3072
  buffer_load_ushort v227, v7, s[56:59], s72 offen offset:3200
  s_add_u32 s72, s72, 4096
  buffer_load_ushort v212, v7, s[56:59], s72 offen offset:0
  buffer_load_ushort v228, v7, s[56:59], s72 offen offset:128
  buffer_load_ushort v213, v7, s[56:59], s72 offen offset:1024
  buffer_load_ushort v229, v7, s[56:59], s72 offen offset:1152
  buffer_load_ushort v214, v7, s[56:59], s72 offen offset:2048
  buffer_load_ushort v230, v7, s[56:59], s72 offen offset:2176
  buffer_load_ushort v215, v7, s[56:59], s72 offen offset:3072
  buffer_load_ushort v231, v7, s[56:59], s72 offen offset:3200
  s_add_u32 s72, s72, 4096
  buffer_load_ushort v216, v7, s[56:59], s72 offen offset:0
  buffer_load_ushort v232, v7, s[56:59], s72 offen offset:128
  buffer_load_ushort v217, v7, s[56:59], s72 offen offset:1024
  buffer_load_ushort v233, v7, s[56:59], s72 offen offset:1152
  buffer_load_ushort v218, v7, s[56:59], s72 offen offset:2048
  buffer_load_ushort v234, v7, s[56:59], s72 offen offset:2176
  buffer_load_ushort v219, v7, s[56:59], s72 offen offset:3072
  buffer_load_ushort v235, v7, s[56:59], s72 offen offset:3200
  s_add_u32 s72, s72, 4096
  buffer_load_ushort v220, v7, s[56:59], s72 offen offset:0
  buffer_load_ushort v236, v7, s[56:59], s72 offen offset:128
  buffer_load_ushort v221, v7, s[56:59], s72 offen offset:1024
  buffer_load_ushort v237, v7, s[56:59], s72 offen offset:1152
  buffer_load_ushort v222, v7, s[56:59], s72 offen offset:2048
  buffer_load_ushort v238, v7, s[56:59], s72 offen offset:2176
  buffer_load_ushort v223, v7, s[56:59], s72 offen offset:3072
  buffer_load_ushort v239, v7, s[56:59], s72 offen offset:3200
  s_branch p2_entry
sl_hook:
  s_cmp_eq_u32 s70, 0
  s_cbranch_scc1 sl_hook_pf
  s_add_u32 s71, s71, 1
  s_cmp_eq_u32 s68, 5
  s_cbranch_scc0 sl_hs
  s_waitcnt vmcnt(0)
  s_mov_b32 s71, 99
  s_branch sl_ret
sl_hs:
  s_cmp_eq_u32 s6, 0
  s_cbranch_scc0 sl_hh
  v_lshlrev_b32 v6, 4, v3
  v_lshl_add_u32 v6, v4, 12, v6
  s_cmp_eq_u32 s68, 2
  s_cbranch_scc0 sl_hw1
  s_waitcnt vmcnt(0)
  v_lshl_or_b32 v176, v209, 16, v208
  v_lshl_or_b32 v177, v211, 16, v210
  v_lshl_or_b32 v178, v213, 16, v212
  v_lshl_or_b32 v179, v215, 16, v214
  buffer_store_dwordx4 v[176:179], v6, s[52:55], s74 offen offset:0 sc1
  v_lshl_or_b32 v180, v217, 16, v216
  v_lshl_or_b32 v181, v219, 16, v218
  v_lshl_or_b32 v182, v221, 16, v220
  v_lshl_or_b32 v183, v223, 16, v222
  buffer_store_dwordx4 v[180:183], v6, s[52:55], s74 offen offset:512 sc1
  s_branch sl_ret
sl_hw1:
  s_add_u32 s74, s74, 8192
  s_mov_b32 s71, 5
  v_lshl_or_b32 v184, v225, 16, v224
  v_lshl_or_b32 v185, v227, 16, v226
  v_lshl_or_b32 v186, v229, 16, v228
  v_lshl_or_b32 v187, v231, 16, v230
  buffer_store_dwordx4 v[184:187], v6, s[52:55], s74 offen offset:0 sc1
  v_lshl_or_b32 v188, v233, 16, v232
  v_lshl_or_b32 v189, v235, 16, v234
  v_lshl_or_b32 v190, v237, 16, v236
  v_lshl_or_b32 v191, v239, 16, v238
  buffer_store_dwordx4 v[188:191], v6, s[52:55], s74 offen offset:512 sc1
  s_branch sl_ret
sl_hh:
  s_cmp_eq_u32 s68, 1
  s_cbranch_scc1 sl_hh1
sl_hh0:
  s_add_u32 s12, s75, 1
  s_lshr_b32 s13, s12, 1
  s_lshl_b32 s13, s13, 14
  s_and_b32 s12, s12, 1
  s_lshl_b32 s12, s12, 11
  s_add_u32 s12, s12, s13
  s_add_u32 s12, s12, s74
  buffer_store_dwordx4 v[184:187], v2, s[52:55], s12 offen offset:0 sc1
  buffer_store_dwordx4 v[188:191], v2, s[52:55], s12 offen offset:1024 sc1
  s_add_u32 s12, s75, 2
  s_lshr_b32 s13, s12, 1
  s_lshl_b32 s13, s13, 14
  s_and_b32 s12, s12, 1
  s_lshl_b32 s12, s12, 11
  s_add_u32 s12, s12, s13
  s_add_u32 s12, s12, s74
  buffer_store_dwordx4 v[192:195], v2, s[52:55], s12 offen offset:0 sc1
  buffer_store_dwordx4 v[196:199], v2, s[52:55], s12 offen offset:1024 sc1
  s_branch sl_ret
sl_hh1:
  s_add_u32 s12, s75, 3
  s_lshr_b32 s13, s12, 1
  s_lshl_b32 s13, s13, 14
  s_and_b32 s12, s12, 1
  s_lshl_b32 s12, s12, 11
  s_add_u32 s12, s12, s13
  s_add_u32 s12, s12, s74
  buffer_store_dwordx4 v[200:203], v2, s[52:55], s12 offen offset:0 sc1
  buffer_store_dwordx4 v[204:207], v2, s[52:55], s12 offen offset:1024 sc1
  s_add_u32 s12, s75, 4
  s_lshr_b32 s13, s12, 1
  s_lshl_b32 s13, s13, 14
  s_and_b32 s12, s12, 1
  s_lshl_b32 s12, s12, 11
  s_add_u32 s12, s12, s13
  s_add_u32 s12, s12, s74
  buffer_store_dwordx4 v[208:211], v2, s[52:55], s12 offen offset:0 sc1
  buffer_store_dwordx4 v[212:215], v2, s[52:55], s12 offen offset:1024 sc1
  s_mov_b32 s71, 5
  s_branch sl_ret
sl_hook_pf:
  s_cmp_eq_u32 s68, 1
  s_cbranch_scc0 sl_hk2
  s_mov_b32 s71, 2
  s_cmp_eq_u32 s3, 0
  s_cbranch_scc0 sl_ret
  s_waitcnt vmcnt(0)
  v_cmp_eq_u32 vcc, 0, v250
  v_mov_b32 v251, 141344
  s_nop 0
  v_cndmask_b32 v250, v250, v252, vcc
  s_mov_b64 exec, 1
  ds_write_b32 v251, v250
  s_mov_b64 exec, -1
  s_waitcnt lgkmcnt(0)
  s_branch sl_ret
sl_hk2:
  s_cmp_eq_u32 s68, 2
  s_cbranch_scc0 sl_hk3
  s_mov_b32 s71, 4
  v_mov_b32 v251, 141344
  ds_read_b32 v250, v251
  s_waitcnt lgkmcnt(0)
  v_readfirstlane_b32 s42, v250
  v_mov_b32 v243, v250
  v_mov_b32 v247, v250
  s_mov_b32 exec_lo, 0x80000000
  s_mov_b32 exec_hi, 0x80000000
  buffer_store_dwordx4 v[240:243], v175, s[52:55], s26 offen sc1
  buffer_store_dwordx4 v[244:247], v175, s[52:55], s27 offen sc1
  s_mov_b64 exec, -1
  s_branch sl_ret
sl_hk3:
  v_lshrrev_b32 v6, 2, v1
  v_and_b32 v7, 3, v1
  v_lshlrev_b32 v6, 10, v6
  v_lshl_add_u32 v6, v7, 6, v6
  buffer_load_dword v255, v6, s[56:59], s72 offen
  s_branch sl_ret
c_h:
  s_mov_b32 s48, s28
  s_and_b32 s49, s29, 0xffff
  s_mov_b32 s50, 0x1c0000
  s_mov_b32 s51, 0x00020000
  s_mul_i32 s10, s4, 114688
  s_mul_i32 s11, s5, 448
  s_add_u32 s10, s10, s11
  s_mul_i32 s11, s3, 112
  s_add_u32 s10, s10, s11
  v_min_u32 v6, 27, v3
  v_lshlrev_b32 v6, 2, v6
  v_mul_u32_u24 v7, 57344, v4
  v_add_u32 v7, v7, v6
  buffer_load_dword v208, v7, s[48:51], s10 offen offset:0
  buffer_load_dword v209, v7, s[48:51], s10 offen offset:3584
  s_add_u32 s10, s10, 7168
  buffer_load_dword v210, v7, s[48:51], s10 offen offset:0
  buffer_load_dword v211, v7, s[48:51], s10 offen offset:3584
  s_add_u32 s10, s10, 7168
  buffer_load_dword v212, v7, s[48:51], s10 offen offset:0
  buffer_load_dword v213, v7, s[48:51], s10 offen offset:3584
  s_add_u32 s10, s10, 7168
  buffer_load_dword v214, v7, s[48:51], s10 offen offset:0
  buffer_load_dword v215, v7, s[48:51], s10 offen offset:3584
  s_add_u32 s10, s10, 7168
  buffer_load_dword v216, v7, s[48:51], s10 offen offset:0
  buffer_load_dword v217, v7, s[48:51], s10 offen offset:3584
  s_add_u32 s10, s10, 7168
  buffer_load_dword v218, v7, s[48:51], s10 offen offset:0
  buffer_load_dword v219, v7, s[48:51], s10 offen offset:3584
  s_add_u32 s10, s10, 7168
  buffer_load_dword v220, v7, s[48:51], s10 offen offset:0
  buffer_load_dword v221, v7, s[48:51], s10 offen offset:3584
  s_add_u32 s10, s10, 7168
  buffer_load_dword v222, v7, s[48:51], s10 offen offset:0
  buffer_load_dword v223, v7, s[48:51], s10 offen offset:3584
  s_cmp_eq_u32 s3, 0
  s_cbranch_scc0 ch_notag
  s_mov_b64 exec, 1
  buffer_atomic_cmpswap v[250:251], v251, s[64:67], 0 offen sc0 sc1
  s_mov_b64 exec, -1
ch_notag:
  s_lshl_b32 s10, s3, 12
  v_xor_b32 v6, 0, v5
  v_add_u32 v24, s10, v6
  v_mov_b32 v16, v24
  v_xor_b32 v6, 32, v5
  v_add_u32 v25, s10, v6
  v_mov_b32 v17, v25
  v_xor_b32 v6, 64, v5
  v_add_u32 v26, s10, v6
  v_mov_b32 v18, v26
  v_xor_b32 v6, 96, v5
  v_add_u32 v27, s10, v6
  v_mov_b32 v19, v27
  v_lshlrev_b32 v6, 3, v4
  v_bfe_u32 v7, v1, 2, 2
  v_add_u32 v6, v6, v7
  v_mul_u32_u24 v6, 448, v6
  v_bfe_u32 v7, v1, 4, 1
  v_lshl_add_u32 v6, v7, 5, v6
  v_and_b32 v7, 3, v1
  v_lshl_add_u32 v6, v7, 3, v6
  v_add_u32 v28, 16384, v6
  v_mov_b32 v20, v28
  v_mov_b32 v96, 0
  v_mov_b32 v97, 0
  v_mov_b32 v98, 0
  v_mov_b32 v99, 0
  v_mov_b32 v100, 0
  v_mov_b32 v101, 0
  v_mov_b32 v102, 0
  v_mov_b32 v103, 0
  v_mov_b32 v104, 0
  v_mov_b32 v105, 0
  v_mov_b32 v106, 0
  v_mov_b32 v107, 0
  v_mov_b32 v108, 0
  v_mov_b32 v109, 0
  v_mov_b32 v110, 0
  v_mov_b32 v111, 0
  v_mov_b32 v112, 0
  v_mov_b32 v113, 0
  v_mov_b32 v114, 0
  v_mov_b32 v115, 0
  v_mov_b32 v116, 0
  v_mov_b32 v117, 0
  v_mov_b32 v118, 0
  v_mov_b32 v119, 0
  v_mov_b32 v120, 0
  v_mov_b32 v121, 0
  v_mov_b32 v122, 0
  v_mov_b32 v123, 0
  v_mov_b32 v124, 0
  v_mov_b32 v125, 0
  v_mov_b32 v126, 0
  v_mov_b32 v127, 0
  v_mov_b32 v128, 0
  v_mov_b32 v129, 0
  v_mov_b32 v130, 0
  v_mov_b32 v131, 0
  v_mov_b32 v132, 0
  v_mov_b32 v133, 0
  v_mov_b32 v134, 0
  v_mov_b32 v135, 0
  v_mov_b32 v136, 0
  v_mov_b32 v137, 0
  v_mov_b32 v138, 0
  v_mov_b32 v139, 0
  v_mov_b32 v140, 0
  v_mov_b32 v141, 0
  v_mov_b32 v142, 0
  v_mov_b32 v143, 0
  v_mov_b32 v144, 0
  v_mov_b32 v145, 0
  v_mov_b32 v146, 0
  v_mov_b32 v147, 0
  v_mov_b32 v148, 0
  v_mov_b32 v149, 0
  v_mov_b32 v150, 0
  v_mov_b32 v151, 0
  v_mov_b32 v152, 0
  v_mov_b32 v153, 0
  v_mov_b32 v154, 0
  v_mov_b32 v155, 0
  v_mov_b32 v156, 0
  v_mov_b32 v157, 0
  v_mov_b32 v158, 0
  v_mov_b32 v159, 0
  v_mov_b32 v160, 0
  v_mov_b32 v161, 0
  v_mov_b32 v162, 0
  v_mov_b32 v163, 0
  v_mov_b32 v164, 0
  v_mov_b32 v165, 0
  v_mov_b32 v166, 0
  v_mov_b32 v167, 0
  v_mov_b32 v168, 0
  v_mov_b32 v169, 0
  v_mov_b32 v170, 0
  v_mov_b32 v171, 0
  v_mov_b32 v172, 0
  v_mov_b32 v173, 0
  v_mov_b32 v174, 0
  v_mov_b32 v175, 0
  v_mov_b32 v176, 0
  v_mov_b32 v177, 0
  v_mov_b32 v178, 0
  v_mov_b32 v179, 0
  v_mov_b32 v180, 0
  v_mov_b32 v181, 0
  v_mov_b32 v182, 0
  v_mov_b32 v183, 0
  v_mov_b32 v184, 0
  v_mov_b32 v185, 0
  v_mov_b32 v186, 0
  v_mov_b32 v187, 0
  v_mov_b32 v188, 0
  v_mov_b32 v189, 0
  v_mov_b32 v190, 0
  v_mov_b32 v191, 0
  v_mov_b32 v192, 0
  v_mov_b32 v193, 0
  v_mov_b32 v194, 0
  v_mov_b32 v195, 0
  v_mov_b32 v196, 0
  v_mov_b32 v197, 0
  v_mov_b32 v198, 0
  v_mov_b32 v199, 0
  v_mov_b32 v200, 0
  v_mov_b32 v201, 0
  v_mov_b32 v202, 0
  v_mov_b32 v203, 0
  v_mov_b32 v204, 0
  v_mov_b32 v205, 0
  v_mov_b32 v206, 0
  v_mov_b32 v207, 0
  v_mov_b32 v60, 0
  v_mov_b32 v61, 0
  v_mov_b32 v62, 0
  v_mov_b32 v63, 0
  v_mov_b32 v64, 0
  v_mov_b32 v65, 0
  v_mov_b32 v66, 0
  v_mov_b32 v67, 0
  v_mov_b32 v68, 0
  v_mov_b32 v69, 0
  v_mov_b32 v70, 0
  v_mov_b32 v71, 0
  v_mov_b32 v72, 0
  v_mov_b32 v73, 0
  v_mov_b32 v74, 0
  v_mov_b32 v75, 0
  v_mov_b32 v76, 0
  v_mov_b32 v77, 0
  v_mov_b32 v78, 0
  v_mov_b32 v79, 0
  v_mov_b32 v80, 0
  v_mov_b32 v81, 0
  v_mov_b32 v82, 0
  v_mov_b32 v83, 0
  v_mov_b32 v84, 0
  v_mov_b32 v85, 0
  v_mov_b32 v86, 0
  v_mov_b32 v87, 0
  v_mov_b32 v92, 0
  v_mov_b32 v93, 0
  v_mov_b32 v94, 0
  v_mov_b32 v95, 0
  s_waitcnt vmcnt(1)
  s_cmp_eq_u32 s3, 0
  s_cbranch_scc1 ch_sw
  s_waitcnt vmcnt(0)
ch_sw:
  v_mov_b32 v238, 0x3f803f80
  v_lshlrev_b32 v239, 4, v4
  v_dot2_f32_bf16 v232, v240, v238, 0
  v_dot2_f32_bf16 v234, v240, v240, 0
  v_dot2_f32_bf16 v233, v241, v238, 0
  v_dot2_f32_bf16 v235, v241, v241, 0
  v_dot2_f32_bf16 v232, v242, v238, v232
  v_dot2_f32_bf16 v234, v242, v242, v234
  v_dot2_f32_bf16 v233, v243, v238, v233
  v_dot2_f32_bf16 v235, v243, v243, v235
  v_dot2_f32_bf16 v232, v244, v238, v232
  v_dot2_f32_bf16 v234, v244, v244, v234
  v_dot2_f32_bf16 v233, v245, v238, v233
  v_dot2_f32_bf16 v235, v245, v245, v235
  v_dot2_f32_bf16 v232, v246, v238, v232
  v_dot2_f32_bf16 v234, v246, v246, v234
  v_dot2_f32_bf16 v233, v247, v238, v233
  v_dot2_f32_bf16 v235, v247, v247, v235
  s_nop 2
  v_add_f32 v232, v232, v233
  v_add_f32 v234, v234, v235
  s_nop 0
  v_add_f32_dpp v232, v232, v232 row_shr:1 row_mask:0xf bank_mask:0xf bound_ctrl:0
  v_add_f32_dpp v234, v234, v234 row_shr:1 row_mask:0xf bank_mask:0xf bound_ctrl:0
  s_nop 0
  v_add_f32_dpp v232, v232, v232 row_shr:2 row_mask:0xf bank_mask:0xf bound_ctrl:0
  v_add_f32_dpp v234, v234, v234 row_shr:2 row_mask:0xf bank_mask:0xf bound_ctrl:0
  s_nop 0
  v_add_f32_dpp v232, v232, v232 row_shr:4 row_mask:0xf bank_mask:0xf bound_ctrl:0
  v_add_f32_dpp v234, v234, v234 row_shr:4 row_mask:0xf bank_mask:0xf bound_ctrl:0
  s_nop 0
  v_add_f32_dpp v232, v232, v232 row_shr:8 row_mask:0xf bank_mask:0xf bound_ctrl:0
  v_add_f32_dpp v234, v234, v234 row_shr:8 row_mask:0xf bank_mask:0xf bound_ctrl:0
  s_nop 0
  v_add_f32_dpp v232, v232, v232 row_bcast:15 row_mask:0xa bank_mask:0xf
  v_add_f32_dpp v234, v234, v234 row_bcast:15 row_mask:0xa bank_mask:0xf
  v_mul_f32 v232, 0x3b000000, v232
  v_mul_f32 v234, 0x3b000000, v234
  v_fma_f32 v234, -v232, v232, v234
  v_max_f32 v234, 0, v234
  v_cvt_pk_bf16_f32 v233, v234, v234
  v_lshlrev_b32 v234, 16, v233
  v_add_f32 v234, 0x3727c5ac, v234
  v_cvt_pk_bf16_f32 v233, v234, v234
  v_lshlrev_b32 v234, 16, v233
  v_sqrt_f32 v234, v234
  v_xor_b32 v232, 0x80000000, v232
  v_cvt_pk_bf16_f32 v240, v232, v232
  v_cvt_pk_bf16_f32 v241, v232, v234
  v_and_b32 v234, 0xffff0000, v241
  v_rcp_f32 v242, v234
  s_lshl_b32 s10, s76, 4
  s_add_u32 s10, s10, 0xf20000
  v_mov_b32 v228, 0x00003f80
  v_mov_b32 v229, 0x3f800000
  s_lshl_b32 s11, s5, 4
  s_add_u32 s11, s11, s4
  s_mul_i32 s11, s11, 1792
  s_mul_i32 s12, s3, 448
  s_add_u32 s11, s11, s12
  s_add_u32 s11, s11, 0xf30000
  v_lshlrev_b32 v230, 4, v3
  v_dot2_f32_bf16 v224, v208, v228, 0
  v_dot2_f32_bf16 v226, v208, v229, 0
  v_dot2_f32_bf16 v225, v209, v228, 0
  v_dot2_f32_bf16 v227, v209, v229, 0
  v_dot2_f32_bf16 v224, v210, v228, v224
  v_dot2_f32_bf16 v226, v210, v229, v226
  v_dot2_f32_bf16 v225, v211, v228, v225
  v_dot2_f32_bf16 v227, v211, v229, v227
  v_dot2_f32_bf16 v224, v212, v228, v224
  v_dot2_f32_bf16 v226, v212, v229, v226
  v_dot2_f32_bf16 v225, v213, v228, v225
  v_dot2_f32_bf16 v227, v213, v229, v227
  v_dot2_f32_bf16 v224, v214, v228, v224
  v_dot2_f32_bf16 v226, v214, v229, v226
  v_dot2_f32_bf16 v225, v215, v228, v225
  v_dot2_f32_bf16 v227, v215, v229, v227
  v_dot2_f32_bf16 v224, v216, v228, v224
  v_dot2_f32_bf16 v226, v216, v229, v226
  v_dot2_f32_bf16 v225, v217, v228, v225
  v_dot2_f32_bf16 v227, v217, v229, v227
  v_dot2_f32_bf16 v224, v218, v228, v224
  v_dot2_f32_bf16 v226, v218, v229, v226
  v_dot2_f32_bf16 v225, v219, v228, v225
  v_dot2_f32_bf16 v227, v219, v229, v227
  v_dot2_f32_bf16 v224, v220, v228, v224
  v_dot2_f32_bf16 v226, v220, v229, v226
  v_dot2_f32_bf16 v225, v221, v228, v225
  v_dot2_f32_bf16 v227, v221, v229, v227
  v_dot2_f32_bf16 v224, v222, v228, v224
  v_dot2_f32_bf16 v226, v222, v229, v226
  v_dot2_f32_bf16 v225, v223, v228, v225
  v_dot2_f32_bf16 v227, v223, v229, v227
  s_nop 2
  v_add_f32 v224, v224, v225
  v_add_f32 v226, v226, v227
  v_mov_b32 v225, v224
  s_nop 1
  v_permlane32_swap_b32 v224, v225
  v_add_f32 v224, v224, v225
  v_mov_b32 v227, v226
  s_nop 1
  v_permlane32_swap_b32 v226, v227
  v_add_f32 v226, v226, v227
  s_mov_b32 s26, s10
  s_mov_b32 s27, s11
  s_setprio 0
  s_mov_b32 s71, 1
  s_mov_b32 s68, 0
  s_mov_b32 s73, 0
h_top:
  s_cmp_eq_u32 s68, s71
  s_cbranch_scc1 h_hook
h_ret:
  s_barrier
  v_mfma_f32_32x32x16_bf16 v[96:111], v[60:63], v[92:95], v[96:111]
  ds_read_b128 v[88:91], v16
  ds_read_b64_tr_b16 v[32:33], v20 offset:0
  ds_read_b64_tr_b16 v[34:35], v20 offset:1792
  v_mfma_f32_32x32x16_bf16 v[112:127], v[64:67], v[92:95], v[112:127]
  ds_read_b64_tr_b16 v[36:37], v20 offset:64
  ds_read_b64_tr_b16 v[38:39], v20 offset:1856
  ds_read_b64_tr_b16 v[40:41], v20 offset:128
  v_mfma_f32_32x32x16_bf16 v[128:143], v[68:71], v[92:95], v[128:143]
  ds_read_b64_tr_b16 v[42:43], v20 offset:1920
  ds_read_b64_tr_b16 v[44:45], v20 offset:192
  ds_read_b64_tr_b16 v[46:47], v20 offset:1984
  v_mfma_f32_32x32x16_bf16 v[144:159], v[72:75], v[92:95], v[144:159]
  ds_read_b64_tr_b16 v[48:49], v20 offset:256
  ds_read_b64_tr_b16 v[50:51], v20 offset:2048
  ds_read_b64_tr_b16 v[52:53], v20 offset:320
  v_mfma_f32_32x32x16_bf16 v[160:175], v[76:79], v[92:95], v[160:175]
  ds_read_b64_tr_b16 v[54:55], v20 offset:2112
  ds_read_b64_tr_b16 v[56:57], v20 offset:384
  ds_read_b64_tr_b16 v[58:59], v20 offset:2176
  v_mfma_f32_32x32x16_bf16 v[176:191], v[80:83], v[92:95], v[176:191]
  v_mfma_f32_32x32x16_bf16 v[192:207], v[84:87], v[92:95], v[192:207]
  s_waitcnt lgkmcnt(6)
  v_mfma_f32_32x32x16_bf16 v[96:111], v[32:35], v[88:91], v[96:111]
  ds_read_b128 v[92:95], v17
  ds_read_b64_tr_b16 v[60:61], v20 offset:7168
  ds_read_b64_tr_b16 v[62:63], v20 offset:8960
  v_mfma_f32_32x32x16_bf16 v[112:127], v[36:39], v[88:91], v[112:127]
  ds_read_b64_tr_b16 v[64:65], v20 offset:7232
  ds_read_b64_tr_b16 v[66:67], v20 offset:9024
  ds_read_b64_tr_b16 v[68:69], v20 offset:7296
  v_mfma_f32_32x32x16_bf16 v[128:143], v[40:43], v[88:91], v[128:143]
  ds_read_b64_tr_b16 v[70:71], v20 offset:9088
  ds_read_b64_tr_b16 v[72:73], v20 offset:7360
  ds_read_b64_tr_b16 v[74:75], v20 offset:9152
  v_mfma_f32_32x32x16_bf16 v[144:159], v[44:47], v[88:91], v[144:159]
  ds_read_b64_tr_b16 v[76:77], v20 offset:7424
  ds_read_b64_tr_b16 v[78:79], v20 offset:9216
  ds_read_b64_tr_b16 v[80:81], v20 offset:7488
  s_waitcnt lgkmcnt(12)
  v_mfma_f32_32x32x16_bf16 v[160:175], v[48:51], v[88:91], v[160:175]
  ds_read_b64_tr_b16 v[82:83], v20 offset:9280
  ds_read_b64_tr_b16 v[84:85], v20 offset:7552
  ds_read_b64_tr_b16 v[86:87], v20 offset:9344
  v_mfma_f32_32x32x16_bf16 v[176:191], v[52:55], v[88:91], v[176:191]
  v_mfma_f32_32x32x16_bf16 v[192:207], v[56:59], v[88:91], v[192:207]
  s_waitcnt lgkmcnt(6)
  v_mfma_f32_32x32x16_bf16 v[96:111], v[60:63], v[92:95], v[96:111]
  ds_read_b128 v[88:91], v18
  ds_read_b64_tr_b16 v[32:33], v20 offset:14336
  ds_read_b64_tr_b16 v[34:35], v20 offset:16128
  v_mfma_f32_32x32x16_bf16 v[112:127], v[64:67], v[92:95], v[112:127]
  ds_read_b64_tr_b16 v[36:37], v20 offset:14400
  ds_read_b64_tr_b16 v[38:39], v20 offset:16192
  ds_read_b64_tr_b16 v[40:41], v20 offset:14464
  v_mfma_f32_32x32x16_bf16 v[128:143], v[68:71], v[92:95], v[128:143]
  ds_read_b64_tr_b16 v[42:43], v20 offset:16256
  ds_read_b64_tr_b16 v[44:45], v20 offset:14528
  ds_read_b64_tr_b16 v[46:47], v20 offset:16320
  v_mfma_f32_32x32x16_bf16 v[144:159], v[72:75], v[92:95], v[144:159]
  ds_read_b64_tr_b16 v[48:49], v20 offset:14592
  ds_read_b64_tr_b16 v[50:51], v20 offset:16384
  ds_read_b64_tr_b16 v[52:53], v20 offset:14656
  s_waitcnt lgkmcnt(12)
  v_mfma_f32_32x32x16_bf16 v[160:175], v[76:79], v[92:95], v[160:175]
  ds_read_b64_tr_b16 v[54:55], v20 offset:16448
  ds_read_b64_tr_b16 v[56:57], v20 offset:14720
  ds_read_b64_tr_b16 v[58:59], v20 offset:16512
  v_mfma_f32_32x32x16_bf16 v[176:191], v[80:83], v[92:95], v[176:191]
  v_mfma_f32_32x32x16_bf16 v[192:207], v[84:87], v[92:95], v[192:207]
  s_waitcnt lgkmcnt(6)
  v_mfma_f32_32x32x16_bf16 v[96:111], v[32:35], v[88:91], v[96:111]
  ds_read_b128 v[92:95], v19
  ds_read_b64_tr_b16 v[60:61], v20 offset:21504
  ds_read_b64_tr_b16 v[62:63], v20 offset:23296
  v_mfma_f32_32x32x16_bf16 v[112:127], v[36:39], v[88:91], v[112:127]
  ds_read_b64_tr_b16 v[64:65], v20 offset:21568
  ds_read_b64_tr_b16 v[66:67], v20 offset:23360
  ds_read_b64_tr_b16 v[68:69], v20 offset:21632
  v_mfma_f32_32x32x16_bf16 v[128:143], v[40:43], v[88:91], v[128:143]
  ds_read_b64_tr_b16 v[70:71], v20 offset:23424
  ds_read_b64_tr_b16 v[72:73], v20 offset:21696
  ds_read_b64_tr_b16 v[74:75], v20 offset:23488
  v_mfma_f32_32x32x16_bf16 v[144:159], v[44:47], v[88:91], v[144:159]
  ds_read_b64_tr_b16 v[76:77], v20 offset:21760
  ds_read_b64_tr_b16 v[78:79], v20 offset:23552
  ds_read_b64_tr_b16 v[80:81], v20 offset:21824
  s_waitcnt lgkmcnt(12)
  v_mfma_f32_32x32x16_bf16 v[160:175], v[48:51], v[88:91], v[160:175]
  ds_read_b64_tr_b16 v[82:83], v20 offset:23616
  ds_read_b64_tr_b16 v[84:85], v20 offset:21888
  ds_read_b64_tr_b16 v[86:87], v20 offset:23680
  v_mfma_f32_32x32x16_bf16 v[176:191], v[52:55], v[88:91], v[176:191]
  s_add_u32 s73, s73, 45056
  s_cmp_eq_u32 s73, 135168
  s_cselect_b32 s73, 0, s73
  v_add_u32 v16, s73, v24
  v_add_u32 v17, s73, v25
  v_add_u32 v18, s73, v26
  v_add_u32 v19, s73, v27
  v_add_u32 v20, s73, v28
  s_add_u32 s68, s68, 1
  s_cmp_lt_u32 s68, 8
  v_mfma_f32_32x32x16_bf16 v[192:207], v[56:59], v[88:91], v[192:207]
  s_waitcnt lgkmcnt(0)
  s_cbranch_scc1 h_top
  v_lshl_add_u32 v6, v3, 4, 0
  v_add_u32 v6, 137216, v6
  s_lshl_b32 s10, s3, 9
  s_add_u32 s10, s10, -2048
  v_add_u32 v7, s10, v6
  v_cmp_eq_u32 vcc, 0, v4
  v_mov_b32 v8, 141312
  s_nop 0
  v_cndmask_b32 v7, v8, v7, vcc
  s_barrier
  v_mfma_f32_32x32x16_bf16 v[96:111], v[60:63], v[92:95], v[96:111]
  ds_read_b128 v[88:91], v7
  ds_read_b128 v[32:35], v6 offset:0
  ds_read_b128 v[36:39], v6 offset:512
  v_mfma_f32_32x32x16_bf16 v[112:127], v[64:67], v[92:95], v[112:127]
  ds_read_b128 v[40:43], v6 offset:1024
  ds_read_b128 v[44:47], v6 offset:1536
  ds_read_b128 v[48:51], v6 offset:2048
  v_mfma_f32_32x32x16_bf16 v[128:143], v[68:71], v[92:95], v[128:143]
  ds_read_b128 v[52:55], v6 offset:2560
  ds_read_b128 v[56:59], v6 offset:3072
  s_lshr_b32 s15, s3, 1
  v_mfma_f32_32x32x16_bf16 v[144:159], v[72:75], v[92:95], v[144:159]
  s_lshr_b32 s14, s7, 1
  s_lshl_b32 s14, s14, 1
  s_add_u32 s14, s14, s15
  v_mfma_f32_32x32x16_bf16 v[160:175], v[76:79], v[92:95], v[160:175]
  s_lshl_b32 s14, s14, 7
  s_add_u32 s14, s14, 141376
  v_lshl_add_u32 v10, v3, 2, s14
  v_mfma_f32_32x32x16_bf16 v[176:191], v[80:83], v[92:95], v[176:191]
  ds_read_b32 v248, v10
  s_lshl_b32 s10, s3, 12
  s_mul_i32 s11, s4, 458752
  v_mfma_f32_32x32x16_bf16 v[192:207], v[84:87], v[92:95], v[192:207]
  s_add_u32 s10, s10, s11
  s_add_u32 s74, s10, 0x400000
  s_mul_i32 s75, s5, 7
  s_waitcnt lgkmcnt(0)
  v_mfma_f32_32x32x16_bf16 v[176:191], v[52:55], v[88:91], v[176:191]
  v_mfma_f32_32x32x16_bf16 v[192:207], v[56:59], v[88:91], v[192:207]
  v_mfma_f32_32x32x16_bf16 v[96:111], v[32:35], v[88:91], v[96:111]
  v_mfma_f32_32x32x16_bf16 v[112:127], v[36:39], v[88:91], v[112:127]
  v_mfma_f32_32x32x16_bf16 v[128:143], v[40:43], v[88:91], v[128:143]
  v_mfma_f32_32x32x16_bf16 v[144:159], v[44:47], v[88:91], v[144:159]
  v_mfma_f32_32x32x16_bf16 v[160:175], v[48:51], v[88:91], v[160:175]
  v_max_f32 v76, 0, v176
  v_max_f32 v77, 0, v177
  v_max_f32 v78, 0, v178
  v_max_f32 v79, 0, v179
  v_pk_mul_f32 v[76:77], v[76:77], v[76:77]
  v_pk_mul_f32 v[78:79], v[78:79], v[78:79]
  v_cvt_pk_bf16_f32 v216, v76, v77
  v_cvt_pk_bf16_f32 v217, v78, v79
  v_max_f32 v80, 0, v180
  v_max_f32 v81, 0, v181
  v_max_f32 v82, 0, v182
  v_max_f32 v83, 0, v183
  v_pk_mul_f32 v[80:81], v[80:81], v[80:81]
  v_pk_mul_f32 v[82:83], v[82:83], v[82:83]
  v_cvt_pk_bf16_f32 v218, v80, v81
  v_cvt_pk_bf16_f32 v219, v82, v83
  s_nop 1
  v_permlane32_swap_b32 v216, v218
  v_permlane32_swap_b32 v217, v219
  v_max_f32 v76, 0, v184
  v_max_f32 v77, 0, v185
  v_max_f32 v78, 0, v186
  v_max_f32 v79, 0, v187
  v_pk_mul_f32 v[76:77], v[76:77], v[76:77]
  v_pk_mul_f32 v[78:79], v[78:79], v[78:79]
  v_cvt_pk_bf16_f32 v220, v76, v77
  v_cvt_pk_bf16_f32 v221, v78, v79
  v_max_f32 v80, 0, v188
  v_max_f32 v81, 0, v189
  v_max_f32 v82, 0, v190
  v_max_f32 v83, 0, v191
  v_pk_mul_f32 v[80:81], v[80:81], v[80:81]
  v_pk_mul_f32 v[82:83], v[82:83], v[82:83]
  v_cvt_pk_bf16_f32 v222, v80, v81
  v_cvt_pk_bf16_f32 v223, v82, v83
  s_nop 1
  v_permlane32_swap_b32 v220, v222
  v_permlane32_swap_b32 v221, v223
  v_max_f32 v76, 0, v192
  v_max_f32 v77, 0, v193
  v_max_f32 v78, 0, v194
  v_max_f32 v79, 0, v195
  v_pk_mul_f32 v[76:77], v[76:77], v[76:77]
  v_pk_mul_f32 v[78:79], v[78:79], v[78:79]
  v_cvt_pk_bf16_f32 v224, v76, v77
  v_cvt_pk_bf16_f32 v225, v78, v79
  v_max_f32 v80, 0, v196
  v_max_f32 v81, 0, v197
  v_max_f32 v82, 0, v198
  v_max_f32 v83, 0, v199
  v_pk_mul_f32 v[80:81], v[80:81], v[80:81]
  v_pk_mul_f32 v[82:83], v[82:83], v[82:83]
  v_cvt_pk_bf16_f32 v226, v80, v81
  v_cvt_pk_bf16_f32 v227, v82, v83
  s_nop 1
  v_permlane32_swap_b32 v224, v226
  v_permlane32_swap_b32 v225, v227
  v_max_f32 v76, 0, v200
  v_max_f32 v77, 0, v201
  v_max_f32 v78, 0, v202
  v_max_f32 v79, 0, v203
  v_pk_mul_f32 v[76:77], v[76:77], v[76:77]
  v_pk_mul_f32 v[78:79], v[78:79], v[78:79]
  v_cvt_pk_bf16_f32 v228, v76, v77
  v_cvt_pk_bf16_f32 v229, v78, v79
  v_max_f32 v80, 0, v204
  v_max_f32 v81, 0, v205
  v_max_f32 v82, 0, v206
  v_max_f32 v83, 0, v207
  v_pk_mul_f32 v[80:81], v[80:81], v[80:81]
  v_pk_mul_f32 v[82:83], v[82:83], v[82:83]
  v_cvt_pk_bf16_f32 v230, v80, v81
  v_cvt_pk_bf16_f32 v231, v82, v83
  s_nop 1
  v_permlane32_swap_b32 v228, v230
  v_permlane32_swap_b32 v229, v231
  v_max_f32 v76, 0, v96
  v_max_f32 v77, 0, v97
  v_max_f32 v78, 0, v98
  v_max_f32 v79, 0, v99
  v_pk_mul_f32 v[76:77], v[76:77], v[76:77]
  v_pk_mul_f32 v[78:79], v[78:79], v[78:79]
  v_cvt_pk_bf16_f32 v176, v76, v77
  v_cvt_pk_bf16_f32 v177, v78, v79
  v_max_f32 v80, 0, v100
  v_max_f32 v81, 0, v101
  v_max_f32 v82, 0, v102
  v_max_f32 v83, 0, v103
  v_pk_mul_f32 v[80:81], v[80:81], v[80:81]
  v_pk_mul_f32 v[82:83], v[82:83], v[82:83]
  v_cvt_pk_bf16_f32 v178, v80, v81
  v_cvt_pk_bf16_f32 v179, v82, v83
  s_nop 1
  v_permlane32_swap_b32 v176, v178
  v_permlane32_swap_b32 v177, v179
  v_max_f32 v76, 0, v104
  v_max_f32 v77, 0, v105
  v_max_f32 v78, 0, v106
  v_max_f32 v79, 0, v107
  v_pk_mul_f32 v[76:77], v[76:77], v[76:77]
  v_pk_mul_f32 v[78:79], v[78:79], v[78:79]
  v_cvt_pk_bf16_f32 v180, v76, v77
  v_cvt_pk_bf16_f32 v181, v78, v79
  v_max_f32 v80, 0, v108
  v_max_f32 v81, 0, v109
  v_max_f32 v82, 0, v110
  v_max_f32 v83, 0, v111
  v_pk_mul_f32 v[80:81], v[80:81], v[80:81]
  v_pk_mul_f32 v[82:83], v[82:83], v[82:83]
  v_cvt_pk_bf16_f32 v182, v80, v81
  v_cvt_pk_bf16_f32 v183, v82, v83
  s_nop 1
  v_permlane32_swap_b32 v180, v182
  v_permlane32_swap_b32 v181, v183
  v_max_f32 v76, 0, v112
  v_max_f32 v77, 0, v113
  v_max_f32 v78, 0, v114
  v_max_f32 v79, 0, v115
  v_pk_mul_f32 v[76:77], v[76:77], v[76:77]
  v_pk_mul_f32 v[78:79], v[78:79], v[78:79]
  v_cvt_pk_bf16_f32 v184, v76, v77
  v_cvt_pk_bf16_f32 v185, v78, v79
  v_max_f32 v80, 0, v116
  v_max_f32 v81, 0, v117
  v_max_f32 v82, 0, v118
  v_max_f32 v83, 0, v119
  v_pk_mul_f32 v[80:81], v[80:81], v[80:81]
  v_pk_mul_f32 v[82:83], v[82:83], v[82:83]
  v_cvt_pk_bf16_f32 v186, v80, v81
  v_cvt_pk_bf16_f32 v187, v82, v83
  s_nop 1
  v_permlane32_swap_b32 v184, v186
  v_permlane32_swap_b32 v185, v187
  v_max_f32 v76, 0, v120
  v_max_f32 v77, 0, v121
  v_max_f32 v78, 0, v122
  v_max_f32 v79, 0, v123
  v_pk_mul_f32 v[76:77], v[76:77], v[76:77]
  v_pk_mul_f32 v[78:79], v[78:79], v[78:79]
  v_cvt_pk_bf16_f32 v188, v76, v77
  v_cvt_pk_bf16_f32 v189, v78, v79
  v_max_f32 v80, 0, v124
  v_max_f32 v81, 0, v125
  v_max_f32 v82, 0, v126
  v_max_f32 v83, 0, v127
  v_pk_mul_f32 v[80:81], v[80:81], v[80:81]
  v_pk_mul_f32 v[82:83], v[82:83], v[82:83]
  v_cvt_pk_bf16_f32 v190, v80, v81
  v_cvt_pk_bf16_f32 v191, v82, v83
  s_nop 1
  v_permlane32_swap_b32 v188, v190
  v_permlane32_swap_b32 v189, v191
  v_max_f32 v76, 0, v128
  v_max_f32 v77, 0, v129
  v_max_f32 v78, 0, v130
  v_max_f32 v79, 0, v131
  v_pk_mul_f32 v[76:77], v[76:77], v[76:77]
  v_pk_mul_f32 v[78:79], v[78:79], v[78:79]
  v_cvt_pk_bf16_f32 v192, v76, v77
  v_cvt_pk_bf16_f32 v193, v78, v79
  v_max_f32 v80, 0, v132
  v_max_f32 v81, 0, v133
  v_max_f32 v82, 0, v134
  v_max_f32 v83, 0, v135
  v_pk_mul_f32 v[80:81], v[80:81], v[80:81]
  v_pk_mul_f32 v[82:83], v[82:83], v[82:83]
  v_cvt_pk_bf16_f32 v194, v80, v81
  v_cvt_pk_bf16_f32 v195, v82, v83
  s_nop 1
  v_permlane32_swap_b32 v192, v194
  v_permlane32_swap_b32 v193, v195
  v_max_f32 v76, 0, v136
  v_max_f32 v77, 0, v137
  v_max_f32 v78, 0, v138
  v_max_f32 v79, 0, v139
  v_pk_mul_f32 v[76:77], v[76:77], v[76:77]
  v_pk_mul_f32 v[78:79], v[78:79], v[78:79]
  v_cvt_pk_bf16_f32 v196, v76, v77
  v_cvt_pk_bf16_f32 v197, v78, v79
  v_max_f32 v80, 0, v140
  v_max_f32 v81, 0, v141
  v_max_f32 v82, 0, v142
  v_max_f32 v83, 0, v143
  v_pk_mul_f32 v[80:81], v[80:81], v[80:81]
  v_pk_mul_f32 v[82:83], v[82:83], v[82:83]
  v_cvt_pk_bf16_f32 v198, v80, v81
  v_cvt_pk_bf16_f32 v199, v82, v83
  s_nop 1
  v_permlane32_swap_b32 v196, v198
  v_permlane32_swap_b32 v197, v199
  v_max_f32 v76, 0, v144
  v_max_f32 v77, 0, v145
  v_max_f32 v78, 0, v146
  v_max_f32 v79, 0, v147
  v_pk_mul_f32 v[76:77], v[76:77], v[76:77]
  v_pk_mul_f32 v[78:79], v[78:79], v[78:79]
  v_cvt_pk_bf16_f32 v200, v76, v77
  v_cvt_pk_bf16_f32 v201, v78, v79
  v_max_f32 v80, 0, v148
  v_max_f32 v81, 0, v149
  v_max_f32 v82, 0, v150
  v_max_f32 v83, 0, v151
  v_pk_mul_f32 v[80:81], v[80:81], v[80:81]
  v_pk_mul_f32 v[82:83], v[82:83], v[82:83]
  v_cvt_pk_bf16_f32 v202, v80, v81
  v_cvt_pk_bf16_f32 v203, v82, v83
  s_nop 1
  v_permlane32_swap_b32 v200, v202
  v_permlane32_swap_b32 v201, v203
  v_max_f32 v76, 0, v152
  v_max_f32 v77, 0, v153
  v_max_f32 v78, 0, v154
  v_max_f32 v79, 0, v155
  v_pk_mul_f32 v[76:77], v[76:77], v[76:77]
  v_pk_mul_f32 v[78:79], v[78:79], v[78:79]
  v_cvt_pk_bf16_f32 v204, v76, v77
  v_cvt_pk_bf16_f32 v205, v78, v79
  v_max_f32 v80, 0, v156
  v_max_f32 v81, 0, v157
  v_max_f32 v82, 0, v158
  v_max_f32 v83, 0, v159
  v_pk_mul_f32 v[80:81], v[80:81], v[80:81]
  v_pk_mul_f32 v[82:83], v[82:83], v[82:83]
  v_cvt_pk_bf16_f32 v206, v80, v81
  v_cvt_pk_bf16_f32 v207, v82, v83
  s_nop 1
  v_permlane32_swap_b32 v204, v206
  v_permlane32_swap_b32 v205, v207
  v_max_f32 v76, 0, v160
  v_max_f32 v77, 0, v161
  v_max_f32 v78, 0, v162
  v_max_f32 v79, 0, v163
  v_pk_mul_f32 v[76:77], v[76:77], v[76:77]
  v_pk_mul_f32 v[78:79], v[78:79], v[78:79]
  v_cvt_pk_bf16_f32 v208, v76, v77
  v_cvt_pk_bf16_f32 v209, v78, v79
  v_max_f32 v80, 0, v164
  v_max_f32 v81, 0, v165
  v_max_f32 v82, 0, v166
  v_max_f32 v83, 0, v167
  v_pk_mul_f32 v[80:81], v[80:81], v[80:81]
  v_pk_mul_f32 v[82:83], v[82:83], v[82:83]
  v_cvt_pk_bf16_f32 v210, v80, v81
  v_cvt_pk_bf16_f32 v211, v82, v83
  s_nop 1
  v_permlane32_swap_b32 v208, v210
  v_permlane32_swap_b32 v209, v211
  v_max_f32 v76, 0, v168
  v_max_f32 v77, 0, v169
  v_max_f32 v78, 0, v170
  v_max_f32 v79, 0, v171
  v_pk_mul_f32 v[76:77], v[76:77], v[76:77]
  v_pk_mul_f32 v[78:79], v[78:79], v[78:79]
  v_cvt_pk_bf16_f32 v212, v76, v77
  v_cvt_pk_bf16_f32 v213, v78, v79
  v_max_f32 v80, 0, v172
  v_max_f32 v81, 0, v173
  v_max_f32 v82, 0, v174
  v_max_f32 v83, 0, v175
  v_pk_mul_f32 v[80:81], v[80:81], v[80:81]
  v_pk_mul_f32 v[82:83], v[82:83], v[82:83]
  v_cvt_pk_bf16_f32 v214, v80, v81
  v_cvt_pk_bf16_f32 v215, v82, v83
  s_nop 1
  v_permlane32_swap_b32 v212, v214
  v_permlane32_swap_b32 v213, v215
  s_nop 1
  s_lshr_b32 s10, s3, 1
  s_and_b32 s11, s3, 1
  s_lshl_b32 s10, s10, 13
  s_lshl_b32 s11, s11, 13
  s_add_u32 s11, s11, 16384
  v_xor_b32 v6, 0, v5
  v_add_u32 v16, s10, v6
  v_add_u32 v20, s11, v2
  s_add_u32 s11, s11, 1024
  v_xor_b32 v6, 32, v5
  v_add_u32 v17, s10, v6
  v_add_u32 v21, s11, v2
  s_add_u32 s11, s11, 1024
  v_xor_b32 v6, 64, v5
  v_add_u32 v18, s10, v6
  v_add_u32 v22, s11, v2
  s_add_u32 s11, s11, 1024
  v_xor_b32 v6, 96, v5
  v_add_u32 v19, s10, v6
  v_add_u32 v23, s11, v2
  v_mov_b32 v96, 0
  v_mov_b32 v97, 0
  v_mov_b32 v98, 0
  v_mov_b32 v99, 0
  v_mov_b32 v100, 0
  v_mov_b32 v101, 0
  v_mov_b32 v102, 0
  v_mov_b32 v103, 0
  v_mov_b32 v104, 0
  v_mov_b32 v105, 0
  v_mov_b32 v106, 0
  v_mov_b32 v107, 0
  v_mov_b32 v108, 0
  v_mov_b32 v109, 0
  v_mov_b32 v110, 0
  v_mov_b32 v111, 0
  v_mov_b32 v112, 0
  v_mov_b32 v113, 0
  v_mov_b32 v114, 0
  v_mov_b32 v115, 0
  v_mov_b32 v116, 0
  v_mov_b32 v117, 0
  v_mov_b32 v118, 0
  v_mov_b32 v119, 0
  v_mov_b32 v120, 0
  v_mov_b32 v121, 0
  v_mov_b32 v122, 0
  v_mov_b32 v123, 0
  v_mov_b32 v124, 0
  v_mov_b32 v125, 0
  v_mov_b32 v126, 0
  v_mov_b32 v127, 0
  v_mov_b32 v128, 0
  v_mov_b32 v129, 0
  v_mov_b32 v130, 0
  v_mov_b32 v131, 0
  v_mov_b32 v132, 0
  v_mov_b32 v133, 0
  v_mov_b32 v134, 0
  v_mov_b32 v135, 0
  v_mov_b32 v136, 0
  v_mov_b32 v137, 0
  v_mov_b32 v138, 0
  v_mov_b32 v139, 0
  v_mov_b32 v140, 0
  v_mov_b32 v141, 0
  v_mov_b32 v142, 0
  v_mov_b32 v143, 0
  v_mov_b32 v144, 0
  v_mov_b32 v145, 0
  v_mov_b32 v146, 0
  v_mov_b32 v147, 0
  v_mov_b32 v148, 0
  v_mov_b32 v149, 0
  v_mov_b32 v150, 0
  v_mov_b32 v151, 0
  v_mov_b32 v152, 0
  v_mov_b32 v153, 0
  v_mov_b32 v154, 0
  v_mov_b32 v155, 0
  v_mov_b32 v156, 0
  v_mov_b32 v157, 0
  v_mov_b32 v158, 0
  v_mov_b32 v159, 0
  v_mov_b32 v64, 0
  v_mov_b32 v65, 0
  v_mov_b32 v66, 0
  v_mov_b32 v67, 0
  v_mov_b32 v68, 0
  v_mov_b32 v69, 0
  v_mov_b32 v70, 0
  v_mov_b32 v71, 0
  v_mov_b32 v72, 0
  v_mov_b32 v73, 0
  v_mov_b32 v74, 0
  v_mov_b32 v75, 0
  v_mov_b32 v76, 0
  v_mov_b32 v77, 0
  v_mov_b32 v78, 0
  v_mov_b32 v79, 0
  v_mov_b32 v80, 0
  v_mov_b32 v81, 0
  v_mov_b32 v82, 0
  v_mov_b32 v83, 0
  v_mov_b32 v84, 0
  v_mov_b32 v85, 0
  v_mov_b32 v86, 0
  v_mov_b32 v87, 0
  v_mov_b32 v88, 0
  v_mov_b32 v89, 0
  v_mov_b32 v90, 0
  v_mov_b32 v91, 0
  v_mov_b32 v92, 0
  v_mov_b32 v93, 0
  v_mov_b32 v94, 0
  v_mov_b32 v95, 0
  s_add_u32 s12, s75, 5
  s_lshr_b32 s13, s12, 1
  s_lshl_b32 s13, s13, 14
  s_and_b32 s12, s12, 1
  s_lshl_b32 s12, s12, 11
  s_add_u32 s12, s12, s13
  s_add_u32 s12, s12, s74
  buffer_store_dwordx4 v[216:219], v2, s[52:55], s12 offen offset:0 sc1
  buffer_store_dwordx4 v[220:223], v2, s[52:55], s12 offen offset:1024 sc1
  s_add_u32 s12, s75, 6
  s_lshr_b32 s13, s12, 1
  s_lshl_b32 s13, s13, 14
  s_and_b32 s12, s12, 1
  s_lshl_b32 s12, s12, 11
  s_add_u32 s12, s12, s13
  s_add_u32 s12, s12, s74
  buffer_store_dwordx4 v[224:227], v2, s[52:55], s12 offen offset:0 sc1
  buffer_store_dwordx4 v[228:231], v2, s[52:55], s12 offen offset:1024 sc1
  s_add_u32 s12, s75, 0
  s_lshr_b32 s13, s12, 1
  s_lshl_b32 s13, s13, 14
  s_and_b32 s12, s12, 1
  s_lshl_b32 s12, s12, 11
  s_add_u32 s12, s12, s13
  s_add_u32 s12, s12, s74
  buffer_store_dwordx4 v[176:179], v2, s[52:55], s12 offen offset:0 sc1
  buffer_store_dwordx4 v[180:183], v2, s[52:55], s12 offen offset:1024 sc1
  s_mov_b32 s71, 0
  s_barrier
p2_entry:
  s_mov_b32 s70, 1
  s_mov_b32 s69, 16
  s_mov_b32 s68, 0
  s_mov_b32 s43, 0
  s_mov_b32 s78, 163840
  s_barrier
  s_branch sl_top
h_hook:
  s_cmp_eq_u32 s68, 1
  s_cbranch_scc0 h_hk2
  s_mov_b32 s71, 2
  s_cmp_eq_u32 s3, 0
  s_cbranch_scc0 h_ret
  s_waitcnt vmcnt(0)
  v_cmp_eq_u32 vcc, 0, v250
  v_mov_b32 v251, 141344
  s_nop 0
  v_cndmask_b32 v250, v250, v252, vcc
  s_mov_b64 exec, 1
  ds_write_b32 v251, v250
  s_mov_b64 exec, -1
  s_waitcnt lgkmcnt(0)
  s_branch h_ret
h_hk2:
  v_mov_b32 v251, 141344
  ds_read_b32 v250, v251
  s_waitcnt lgkmcnt(0)
  v_readfirstlane_b32 s42, v250
  v_mov_b32 v243, v250
  v_mov_b32 v247, v250
  v_mov_b32 v225, v250
  v_mov_b32 v227, v250
  s_mov_b64 exec, 0x0fffffff
  buffer_store_dwordx4 v[224:227], v230, s[52:55], s27 offen sc1
  s_mov_b32 exec_lo, 0x80000000
  s_mov_b32 exec_hi, 0x80000000
  buffer_store_dwordx4 v[240:243], v239, s[52:55], s26 offen sc1
  s_mov_b64 exec, -1
  s_branch h_ret
s_exit:
  v_mfma_f32_32x32x16_bf16 v[96:111], v[72:75], v[64:67], v[96:111]
  s_lshr_b32 s10, s3, 1
  s_and_b32 s11, s3, 1
  s_lshl_b32 s12, s10, 12
  s_lshl_b32 s13, s11, 12
  v_mfma_f32_32x32x16_bf16 v[112:127], v[76:79], v[64:67], v[112:127]
  s_add_u32 s13, s13, 16384
  s_add_u32 s12, s12, s43
  s_add_u32 s13, s13, s43
  v_add_u32 v16, s12, v2
  v_mfma_f32_32x32x16_bf16 v[128:143], v[72:75], v[68:71], v[128:143]
  v_add_u32 v17, s13, v2
  s_lshl_b32 s12, s9, 2
  s_add_u32 s12, s12, s3
  s_lshl_b32 s12, s12, 2
  v_mfma_f32_32x32x16_bf16 v[144:159], v[76:79], v[68:71], v[144:159]
  s_add_u32 s12, s12, s7
  s_lshl_b32 s12, s12, 14
  s_add_u32 s77, s12, 0x1000000
  s_lshr_b32 s13, s7, 1
  v_mfma_f32_32x32x16_bf16 v[96:111], v[88:91], v[80:83], v[96:111]
  s_lshl_b32 s13, s13, 1
  s_add_u32 s13, s13, s10
  s_lshl_b32 s76, s13, 7
  s_lshl_b32 s13, s13, 15
  v_mfma_f32_32x32x16_bf16 v[112:127], v[92:95], v[80:83], v[112:127]
  s_lshl_b32 s14, s4, 17
  s_add_u32 s13, s13, s14
  s_and_b32 s14, s7, 1
  s_lshl_b32 s14, s14, 1
  v_mfma_f32_32x32x16_bf16 v[128:143], v[88:91], v[84:87], v[128:143]
  s_add_u32 s14, s14, s11
  s_lshl_b32 s14, s14, 6
  s_lshl_b32 s15, s8, 8
  s_add_u32 s75, s14, s15
  v_mfma_f32_32x32x16_bf16 v[144:159], v[92:95], v[84:87], v[144:159]
  s_add_u32 s74, s13, s75
  s_mov_b32 s44, s16
  s_and_b32 s45, s17, 0xffff
  s_mov_b32 s46, 0x200000
  s_mov_b32 s47, 0x00020000
  s_mov_b32 s56, s34
  s_and_b32 s57, s35, 0xffff
  s_mov_b32 s58, 0x400
  s_mov_b32 s59, 0x00020000
  v_lshlrev_b32 v24, 3, v4
  v_lshl_add_u32 v25, v3, 10, v24
  s_nop 3
  v_cvt_pk_bf16_f32 v96, v96, v97
  v_cvt_pk_bf16_f32 v97, v98, v99
  v_cvt_pk_bf16_f32 v98, v100, v101
  v_cvt_pk_bf16_f32 v99, v102, v103
  v_cvt_pk_bf16_f32 v100, v104, v105
  v_cvt_pk_bf16_f32 v101, v106, v107
  v_cvt_pk_bf16_f32 v102, v108, v109
  v_cvt_pk_bf16_f32 v103, v110, v111
  v_cvt_pk_bf16_f32 v104, v112, v113
  v_cvt_pk_bf16_f32 v105, v114, v115
  v_cvt_pk_bf16_f32 v106, v116, v117
  v_cvt_pk_bf16_f32 v107, v118, v119
  v_cvt_pk_bf16_f32 v108, v120, v121
  v_cvt_pk_bf16_f32 v109, v122, v123
  v_cvt_pk_bf16_f32 v110, v124, v125
  v_cvt_pk_bf16_f32 v111, v126, v127
  v_cvt_pk_bf16_f32 v112, v128, v129
  v_cvt_pk_bf16_f32 v113, v130, v131
  v_cvt_pk_bf16_f32 v114, v132, v133
  v_cvt_pk_bf16_f32 v115, v134, v135
  v_cvt_pk_bf16_f32 v116, v136, v137
  v_cvt_pk_bf16_f32 v117, v138, v139
  v_cvt_pk_bf16_f32 v118, v140, v141
  v_cvt_pk_bf16_f32 v119, v142, v143
  v_cvt_pk_bf16_f32 v120, v144, v145
  v_cvt_pk_bf16_f32 v121, v146, v147
  v_cvt_pk_bf16_f32 v122, v148, v149
  v_cvt_pk_bf16_f32 v123, v150, v151
  v_cvt_pk_bf16_f32 v124, v152, v153
  v_cvt_pk_bf16_f32 v125, v154, v155
  v_cvt_pk_bf16_f32 v126, v156, v157
  v_cvt_pk_bf16_f32 v127, v158, v159
  buffer_store_dwordx4 v[96:99], v2, s[52:55], s77 offen offset:0 sc1
  buffer_store_dwordx4 v[100:103], v2, s[52:55], s77 offen offset:1024 sc1
  buffer_load_dwordx2 v[224:225], v25, s[44:47], s74 offen offset:0
  buffer_load_dwordx2 v[226:227], v25, s[44:47], s74 offen offset:16
  buffer_load_dwordx2 v[228:229], v25, s[44:47], s74 offen offset:32
  buffer_load_dwordx2 v[230:231], v25, s[44:47], s74 offen offset:48
  buffer_load_dwordx2 v[232:233], v24, s[56:59], s75 offen offset:0
  buffer_load_dwordx2 v[234:235], v24, s[56:59], s75 offen offset:16
  buffer_load_dwordx2 v[236:237], v24, s[56:59], s75 offen offset:32
  buffer_load_dwordx2 v[238:239], v24, s[56:59], s75 offen offset:48
  v_mov_b32 v160, 0
  v_mov_b32 v161, 0
  v_mov_b32 v162, 0
  v_mov_b32 v163, 0
  v_mov_b32 v164, 0
  v_mov_b32 v165, 0
  v_mov_b32 v166, 0
  v_mov_b32 v167, 0
  v_mov_b32 v168, 0
  v_mov_b32 v169, 0
  v_mov_b32 v170, 0
  v_mov_b32 v171, 0
  v_mov_b32 v172, 0
  v_mov_b32 v173, 0
  v_mov_b32 v174, 0
  v_mov_b32 v175, 0
  v_mov_b32 v64, 0
  v_mov_b32 v65, 0
  v_mov_b32 v66, 0
  v_mov_b32 v67, 0
  v_mov_b32 v68, 0
  v_mov_b32 v69, 0
  v_mov_b32 v70, 0
  v_mov_b32 v71, 0
  v_mov_b32 v72, 0
  v_mov_b32 v73, 0
  v_mov_b32 v74, 0
  v_mov_b32 v75, 0
  v_mov_b32 v76, 0
  v_mov_b32 v77, 0
  v_mov_b32 v78, 0
  v_mov_b32 v79, 0
  v_mov_b32 v80, 0
  v_mov_b32 v81, 0
  v_mov_b32 v82, 0
  v_mov_b32 v83, 0
  v_mov_b32 v84, 0
  v_mov_b32 v85, 0
  v_mov_b32 v86, 0
  v_mov_b32 v87, 0
  v_mov_b32 v88, 0
  v_mov_b32 v89, 0
  v_mov_b32 v90, 0
  v_mov_b32 v91, 0
  v_mov_b32 v92, 0
  v_mov_b32 v93, 0
  v_mov_b32 v94, 0
  v_mov_b32 v95, 0
  s_mov_b32 s68, 0
  s_mov_b32 s72, 0
  s_mov_b32 s71, 1
  s_lshl_b32 s10, s9, 2
  s_add_u32 s10, s10, s7
  s_lshl_b32 s73, s10, 7
  s_add_u32 s73, s73, 0xf00000
  s_lshl_b32 s10, s10, 16
  s_lshl_b32 s11, s3, 11
  s_add_u32 s10, s10, s11
  s_add_u32 s69, s10, 0x1000000
  v_mov_b32 v27, 0
  v_and_b32 v29, 3, v1
  v_lshlrev_b32 v29, 2, v29
ol_top:
  s_cmp_eq_u32 s68, s71
  s_cbranch_scc1 ol_hook
ol_ret:
  s_barrier
  v_mfma_f32_32x32x16_bf16 v[160:175], v[68:71], v[64:67], v[160:175]
  ds_read_b128 v[32:35], v16 offset:0
  ds_read_b128 v[36:39], v17 offset:0
  v_mfma_f32_32x32x16_bf16 v[160:175], v[76:79], v[72:75], v[160:175]
  ds_read_b128 v[40:43], v16 offset:1024
  ds_read_b128 v[44:47], v17 offset:1024
  v_mfma_f32_32x32x16_bf16 v[160:175], v[84:87], v[80:83], v[160:175]
  ds_read_b128 v[48:51], v16 offset:2048
  ds_read_b128 v[52:55], v17 offset:2048
  v_mfma_f32_32x32x16_bf16 v[160:175], v[92:95], v[88:91], v[160:175]
  ds_read_b128 v[56:59], v16 offset:3072
  ds_read_b128 v[60:63], v17 offset:3072
  s_waitcnt lgkmcnt(6)
  v_mfma_f32_32x32x16_bf16 v[160:175], v[36:39], v[32:35], v[160:175]
  ds_read_b128 v[64:67], v16 offset:8192
  ds_read_b128 v[68:71], v17 offset:8192
  s_waitcnt lgkmcnt(6)
  v_mfma_f32_32x32x16_bf16 v[160:175], v[44:47], v[40:43], v[160:175]
  ds_read_b128 v[72:75], v16 offset:9216
  ds_read_b128 v[76:79], v17 offset:9216
  s_waitcnt lgkmcnt(6)
  v_mfma_f32_32x32x16_bf16 v[160:175], v[52:55], v[48:51], v[160:175]
  ds_read_b128 v[80:83], v16 offset:10240
  ds_read_b128 v[84:87], v17 offset:10240
  s_waitcnt lgkmcnt(6)
  v_mfma_f32_32x32x16_bf16 v[160:175], v[60:63], v[56:59], v[160:175]
  ds_read_b128 v[88:91], v16 offset:11264
  ds_read_b128 v[92:95], v17 offset:11264
  s_add_u32 s43, s43, 32768
  s_cmp_eq_u32 s43, s78
  s_cselect_b32 s10, s78, 0
  s_sub_u32 s43, s43, s10
  s_sub_u32 s10, 32768, s10
  v_add_u32 v16, s10, v16
  v_add_u32 v17, s10, v17
  s_add_u32 s68, s68, 1
  s_cmp_lt_u32 s68, 14
  s_waitcnt lgkmcnt(0)
  s_cbranch_scc1 ol_top
  v_mfma_f32_32x32x16_bf16 v[160:175], v[68:71], v[64:67], v[160:175]
  v_mfma_f32_32x32x16_bf16 v[160:175], v[76:79], v[72:75], v[160:175]
  v_mfma_f32_32x32x16_bf16 v[160:175], v[84:87], v[80:83], v[160:175]
  v_mfma_f32_32x32x16_bf16 v[160:175], v[92:95], v[88:91], v[160:175]
  s_mov_b32 s64, s36
  s_and_b32 s65, s37, 0xffff
  s_mov_b32 s66, 0x200000
  s_mov_b32 s67, 0x00020000
  s_cmp_eq_u32 s72, 2
  s_cbranch_scc1 fin_go
  s_mov_b32 s68, 0
fin_poll:
  buffer_load_dword v28, v29, s[52:55], s73 offen sc1
  s_waitcnt vmcnt(0)
  v_cmp_ne_u32 vcc, s42, v28
  s_add_u32 s68, s68, 1
  s_nop 3
  s_cmp_eq_u64 vcc, 0
  s_cbranch_scc1 fin_ld
  s_sleep 1
  s_cmp_lt_u32 s68, 200000
  s_cbranch_scc1 fin_poll
fin_ld:
  s_add_u32 s10, s7, 0
  s_and_b32 s10, s10, 3
  s_lshl_b32 s10, s10, 14
  s_add_u32 s10, s10, s69
  buffer_load_dwordx4 v[176:179], v2, s[52:55], s10 offen offset:0 sc1
  buffer_load_dwordx4 v[180:183], v2, s[52:55], s10 offen offset:1024 sc1
  s_add_u32 s10, s7, 1
  s_and_b32 s10, s10, 3
  s_lshl_b32 s10, s10, 14
  s_add_u32 s10, s10, s69
  buffer_load_dwordx4 v[184:187], v2, s[52:55], s10 offen offset:0 sc1
  buffer_load_dwordx4 v[188:191], v2, s[52:55], s10 offen offset:1024 sc1
  s_add_u32 s10, s7, 2
  s_and_b32 s10, s10, 3
  s_lshl_b32 s10, s10, 14
  s_add_u32 s10, s10, s69
  buffer_load_dwordx4 v[192:195], v2, s[52:55], s10 offen offset:0 sc1
  buffer_load_dwordx4 v[196:199], v2, s[52:55], s10 offen offset:1024 sc1
  s_add_u32 s10, s7, 3
  s_and_b32 s10, s10, 3
  s_lshl_b32 s10, s10, 14
  s_add_u32 s10, s10, s69
  buffer_load_dwordx4 v[200:203], v2, s[52:55], s10 offen offset:0 sc1
  buffer_load_dwordx4 v[204:207], v2, s[52:55], s10 offen offset:1024 sc1
fin_go:
  s_mov_b32 s12, 0xffff0000
  s_mov_b32 s13, 0xbfb8aa3b
  v_lshlrev_b32 v24, 4, v4
  v_lshl_add_u32 v25, v3, 10, v24
  v_mul_f32 v8, v248, v248
  v_mov_b32 v9, v8
  s_waitcnt vmcnt(8)
  v_mov_b32 v10, 0x00003f80
  v_mov_b32 v11, 0x3f800000
  v_lshlrev_b32 v48, 16, v232
  v_and_b32 v49, s12, v232
  v_lshlrev_b32 v50, 16, v233
  v_and_b32 v51, s12, v233
  v_lshlrev_b32 v52, 16, v234
  v_and_b32 v53, s12, v234
  v_lshlrev_b32 v54, 16, v235
  v_and_b32 v55, s12, v235
  v_lshlrev_b32 v56, 16, v236
  v_and_b32 v57, s12, v236
  v_lshlrev_b32 v58, 16, v237
  v_and_b32 v59, s12, v237
  v_lshlrev_b32 v60, 16, v238
  v_and_b32 v61, s12, v238
  v_lshlrev_b32 v62, 16, v239
  v_and_b32 v63, s12, v239
  v_pk_fma_f32 v[160:161], v[160:161], v[8:9], v[48:49]
  v_pk_fma_f32 v[162:163], v[162:163], v[8:9], v[50:51]
  v_pk_fma_f32 v[164:165], v[164:165], v[8:9], v[52:53]
  v_pk_fma_f32 v[166:167], v[166:167], v[8:9], v[54:55]
  v_pk_fma_f32 v[168:169], v[168:169], v[8:9], v[56:57]
  v_pk_fma_f32 v[170:171], v[170:171], v[8:9], v[58:59]
  v_pk_fma_f32 v[172:173], v[172:173], v[8:9], v[60:61]
  v_pk_fma_f32 v[174:175], v[174:175], v[8:9], v[62:63]
  v_mul_f32 v64, s13, v160
  v_mul_f32 v65, s13, v161
  v_mul_f32 v66, s13, v162
  v_mul_f32 v67, s13, v163
  v_mul_f32 v68, s13, v164
  v_mul_f32 v69, s13, v165
  v_mul_f32 v70, s13, v166
  v_mul_f32 v71, s13, v167
  v_mul_f32 v72, s13, v168
  v_mul_f32 v73, s13, v169
  v_mul_f32 v74, s13, v170
  v_mul_f32 v75, s13, v171
  v_mul_f32 v76, s13, v172
  v_mul_f32 v77, s13, v173
  v_mul_f32 v78, s13, v174
  v_mul_f32 v79, s13, v175
  v_exp_f32 v64, v64
  v_exp_f32 v65, v65
  v_exp_f32 v66, v66
  v_exp_f32 v67, v67
  v_exp_f32 v68, v68
  v_exp_f32 v69, v69
  v_exp_f32 v70, v70
  v_exp_f32 v71, v71
  v_exp_f32 v72, v72
  v_exp_f32 v73, v73
  v_exp_f32 v74, v74
  v_exp_f32 v75, v75
  v_exp_f32 v76, v76
  v_exp_f32 v77, v77
  v_exp_f32 v78, v78
  v_exp_f32 v79, v79
  v_add_f32 v64, 1.0, v64
  v_add_f32 v65, 1.0, v65
  v_add_f32 v66, 1.0, v66
  v_add_f32 v67, 1.0, v67
  v_add_f32 v68, 1.0, v68
  v_add_f32 v69, 1.0, v69
  v_add_f32 v70, 1.0, v70
  v_add_f32 v71, 1.0, v71
  v_add_f32 v72, 1.0, v72
  v_add_f32 v73, 1.0, v73
  v_add_f32 v74, 1.0, v74
  v_add_f32 v75, 1.0, v75
  v_add_f32 v76, 1.0, v76
  v_add_f32 v77, 1.0, v77
  v_add_f32 v78, 1.0, v78
  v_add_f32 v79, 1.0, v79
  v_rcp_f32 v64, v64
  v_rcp_f32 v65, v65
  v_rcp_f32 v66, v66
  v_rcp_f32 v67, v67
  v_rcp_f32 v68, v68
  v_rcp_f32 v69, v69
  v_rcp_f32 v70, v70
  v_rcp_f32 v71, v71
  v_rcp_f32 v72, v72
  v_rcp_f32 v73, v73
  v_rcp_f32 v74, v74
  v_rcp_f32 v75, v75
  v_rcp_f32 v76, v76
  v_rcp_f32 v77, v77
  v_rcp_f32 v78, v78
  v_rcp_f32 v79, v79
  v_lshlrev_b32 v48, 16, v224
  v_and_b32 v49, s12, v224
  v_lshlrev_b32 v50, 16, v225
  v_and_b32 v51, s12, v225
  v_lshlrev_b32 v52, 16, v226
  v_and_b32 v53, s12, v226
  v_lshlrev_b32 v54, 16, v227
  v_and_b32 v55, s12, v227
  v_lshlrev_b32 v56, 16, v228
  v_and_b32 v57, s12, v228
  v_lshlrev_b32 v58, 16, v229
  v_and_b32 v59, s12, v229
  v_lshlrev_b32 v60, 16, v230
  v_and_b32 v61, s12, v230
  v_lshlrev_b32 v62, 16, v231
  v_and_b32 v63, s12, v231
  v_pk_mul_f32 v[160:161], v[160:161], v[64:65]
  v_pk_mul_f32 v[162:163], v[162:163], v[66:67]
  v_pk_mul_f32 v[164:165], v[164:165], v[68:69]
  v_pk_mul_f32 v[166:167], v[166:167], v[70:71]
  v_pk_mul_f32 v[168:169], v[168:169], v[72:73]
  v_pk_mul_f32 v[170:171], v[170:171], v[74:75]
  v_pk_mul_f32 v[172:173], v[172:173], v[76:77]
  v_pk_mul_f32 v[174:175], v[174:175], v[78:79]
  s_waitcnt vmcnt(0)
  v_dot2_f32_bf16 v32, v176, v10, 0
  v_dot2_f32_bf16 v33, v176, v11, 0
  v_dot2_f32_bf16 v34, v177, v10, 0
  v_dot2_f32_bf16 v35, v177, v11, 0
  v_dot2_f32_bf16 v36, v178, v10, 0
  v_dot2_f32_bf16 v37, v178, v11, 0
  v_dot2_f32_bf16 v38, v179, v10, 0
  v_dot2_f32_bf16 v39, v179, v11, 0
  v_dot2_f32_bf16 v40, v180, v10, 0
  v_dot2_f32_bf16 v41, v180, v11, 0
  v_dot2_f32_bf16 v42, v181, v10, 0
  v_dot2_f32_bf16 v43, v181, v11, 0
  v_dot2_f32_bf16 v44, v182, v10, 0
  v_dot2_f32_bf16 v45, v182, v11, 0
  v_dot2_f32_bf16 v46, v183, v10, 0
  v_dot2_f32_bf16 v47, v183, v11, 0
  v_dot2_f32_bf16 v32, v184, v10, v32
  v_dot2_f32_bf16 v33, v184, v11, v33
  v_dot2_f32_bf16 v34, v185, v10, v34
  v_dot2_f32_bf16 v35, v185, v11, v35
  v_dot2_f32_bf16 v36, v186, v10, v36
  v_dot2_f32_bf16 v37, v186, v11, v37
  v_dot2_f32_bf16 v38, v187, v10, v38
  v_dot2_f32_bf16 v39, v187, v11, v39
  v_dot2_f32_bf16 v40, v188, v10, v40
  v_dot2_f32_bf16 v41, v188, v11, v41
  v_dot2_f32_bf16 v42, v189, v10, v42
  v_dot2_f32_bf16 v43, v189, v11, v43
  v_dot2_f32_bf16 v44, v190, v10, v44
  v_dot2_f32_bf16 v45, v190, v11, v45
  v_dot2_f32_bf16 v46, v191, v10, v46
  v_dot2_f32_bf16 v47, v191, v11, v47
  v_dot2_f32_bf16 v32, v192, v10, v32
  v_dot2_f32_bf16 v33, v192, v11, v33
  v_dot2_f32_bf16 v34, v193, v10, v34
  v_dot2_f32_bf16 v35, v193, v11, v35
  v_dot2_f32_bf16 v36, v194, v10, v36
  v_dot2_f32_bf16 v37, v194, v11, v37
  v_dot2_f32_bf16 v38, v195, v10, v38
  v_dot2_f32_bf16 v39, v195, v11, v39
  v_dot2_f32_bf16 v40, v196, v10, v40
  v_dot2_f32_bf16 v41, v196, v11, v41
  v_dot2_f32_bf16 v42, v197, v10, v42
  v_dot2_f32_bf16 v43, v197, v11, v43
  v_dot2_f32_bf16 v44, v198, v10, v44
  v_dot2_f32_bf16 v45, v198, v11, v45
  v_dot2_f32_bf16 v46, v199, v10, v46
  v_dot2_f32_bf16 v47, v199, v11, v47
  v_dot2_f32_bf16 v32, v200, v10, v32
  v_dot2_f32_bf16 v33, v200, v11, v33
  v_dot2_f32_bf16 v34, v201, v10, v34
  v_dot2_f32_bf16 v35, v201, v11, v35
  v_dot2_f32_bf16 v36, v202, v10, v36
  v_dot2_f32_bf16 v37, v202, v11, v37
  v_dot2_f32_bf16 v38, v203, v10, v38
  v_dot2_f32_bf16 v39, v203, v11, v39
  v_dot2_f32_bf16 v40, v204, v10, v40
  v_dot2_f32_bf16 v41, v204, v11, v41
  v_dot2_f32_bf16 v42, v205, v10, v42
  v_dot2_f32_bf16 v43, v205, v11, v43
  v_dot2_f32_bf16 v44, v206, v10, v44
  v_dot2_f32_bf16 v45, v206, v11, v45
  v_dot2_f32_bf16 v46, v207, v10, v46
  v_dot2_f32_bf16 v47, v207, v11, v47
  s_nop 2
  v_pk_fma_f32 v[32:33], v[32:33], v[160:161], v[48:49]
  v_pk_fma_f32 v[34:35], v[34:35], v[162:163], v[50:51]
  v_pk_fma_f32 v[36:37], v[36:37], v[164:165], v[52:53]
  v_pk_fma_f32 v[38:39], v[38:39], v[166:167], v[54:55]
  v_pk_fma_f32 v[40:41], v[40:41], v[168:169], v[56:57]
  v_pk_fma_f32 v[42:43], v[42:43], v[170:171], v[58:59]
  v_pk_fma_f32 v[44:45], v[44:45], v[172:173], v[60:61]
  v_pk_fma_f32 v[46:47], v[46:47], v[174:175], v[62:63]
  v_cvt_pk_bf16_f32 v64, v32, v33
  v_cvt_pk_bf16_f32 v65, v34, v35
  v_cvt_pk_bf16_f32 v66, v36, v37
  v_cvt_pk_bf16_f32 v67, v38, v39
  s_nop 1
  v_permlane32_swap_b32 v64, v66
  v_permlane32_swap_b32 v65, v67
  buffer_store_dwordx4 v[64:67], v25, s[64:67], s74 offen offset:0
  v_cvt_pk_bf16_f32 v68, v40, v41
  v_cvt_pk_bf16_f32 v69, v42, v43
  v_cvt_pk_bf16_f32 v70, v44, v45
  v_cvt_pk_bf16_f32 v71, v46, v47
  s_nop 1
  v_permlane32_swap_b32 v68, v70
  v_permlane32_swap_b32 v69, v71
  buffer_store_dwordx4 v[68:71], v25, s[64:67], s74 offen offset:32
  s_endpgm
ol_hook:
  s_cmp_eq_u32 s68, 1
  s_cbranch_scc1 ol_ps1
  s_cmp_eq_u32 s68, 2
  s_cbranch_scc1 ol_ps2
  s_cmp_eq_u32 s68, 3
  s_cbranch_scc1 ol_ps3
  s_cmp_eq_u32 s68, 6
  s_cbranch_scc0 ol_h2
  s_waitcnt vmcnt(0)
  v_mov_b32 v28, s42
  s_mov_b64 exec, 1
  buffer_store_dword v28, v27, s[52:55], s79 offen sc1
  s_mov_b64 exec, -1
  s_mov_b32 s71, 8
  s_branch ol_ret
ol_h2:
  s_cmp_eq_u32 s72, 0
  s_cbranch_scc1 ol_h3
  s_waitcnt vmcnt(0)
  v_cmp_ne_u32 vcc, s42, v28
  s_nop 4
  s_cmp_eq_u64 vcc, 0
  s_cbranch_scc0 ol_h3
  s_add_u32 s10, s7, 0
  s_and_b32 s10, s10, 3
  s_lshl_b32 s10, s10, 14
  s_add_u32 s10, s10, s69
  buffer_load_dwordx4 v[176:179], v2, s[52:55], s10 offen offset:0 sc1
  buffer_load_dwordx4 v[180:183], v2, s[52:55], s10 offen offset:1024 sc1
  s_add_u32 s10, s7, 1
  s_and_b32 s10, s10, 3
  s_lshl_b32 s10, s10, 14
  s_add_u32 s10, s10, s69
  buffer_load_dwordx4 v[184:187], v2, s[52:55], s10 offen offset:0 sc1
  buffer_load_dwordx4 v[188:191], v2, s[52:55], s10 offen offset:1024 sc1
  s_add_u32 s10, s7, 2
  s_and_b32 s10, s10, 3
  s_lshl_b32 s10, s10, 14
  s_add_u32 s10, s10, s69
  buffer_load_dwordx4 v[192:195], v2, s[52:55], s10 offen offset:0 sc1
  buffer_load_dwordx4 v[196:199], v2, s[52:55], s10 offen offset:1024 sc1
  s_add_u32 s10, s7, 3
  s_and_b32 s10, s10, 3
  s_lshl_b32 s10, s10, 14
  s_add_u32 s10, s10, s69
  buffer_load_dwordx4 v[200:203], v2, s[52:55], s10 offen offset:0 sc1
  buffer_load_dwordx4 v[204:207], v2, s[52:55], s10 offen offset:1024 sc1
  s_mov_b32 s72, 2
  s_branch ol_ret
ol_h3:
  buffer_load_dword v28, v29, s[52:55], s73 offen sc1
  s_mov_b32 s72, 1
  s_add_u32 s71, s68, 3
  s_branch ol_ret
ol_ps1:
  buffer_store_dwordx4 v[104:107], v2, s[52:55], s77 offen offset:2048 sc1
  buffer_store_dwordx4 v[108:111], v2, s[52:55], s77 offen offset:3072 sc1
  s_mov_b32 s71, 2
  s_branch ol_ret
ol_ps2:
  s_add_u32 s77, s77, 4096
  buffer_store_dwordx4 v[112:115], v2, s[52:55], s77 offen offset:0 sc1
  buffer_store_dwordx4 v[116:119], v2, s[52:55], s77 offen offset:1024 sc1
  s_mov_b32 s71, 3
  s_branch ol_ret
ol_ps3:
  buffer_store_dwordx4 v[120:123], v2, s[52:55], s77 offen offset:2048 sc1
  buffer_store_dwordx4 v[124:127], v2, s[52:55], s77 offen offset:3072 sc1
  s_mov_b32 s71, 6
  s_branch ol_ret
k_helper:
  s_sub_u32 s3, s3, 4
  v_lshrrev_b32 v6, 3, v1
  v_lshlrev_b32 v6, 10, v6
  v_lshrrev_b32 v7, 4, v1
  v_and_b32 v9, 7, v1
  v_xor_b32 v7, v7, v9
  v_lshl_add_u32 v16, v7, 4, v6
  v_xor_b32 v17, 64, v16
  v_add_u32 v17, 7168, v17
  v_add_u32 v18, 14336, v16
  v_add_u32 v19, 14336, v17
  s_lshl_b32 s76, s3, 12
  s_lshl_b32 s10, s4, 17
  s_lshl_b32 s11, s3, 15
  s_add_u32 s74, s10, s11
  s_mov_b32 s68, 1
  s_mov_b32 s73, 0
  s_add_u32 s71, s8, s4
  s_and_b32 s71, s71, 1
  s_lshl_b32 s71, s71, 7
  s_waitcnt lgkmcnt(0)
  s_mov_b32 s44, s16
  s_and_b32 s45, s17, 0xffff
  s_mov_b32 s46, 0x200000
  s_mov_b32 s47, 0x00020000
  s_mov_b32 s52, s40
  s_and_b32 s53, s41, 0xffff
  s_mov_b32 s54, 0x2000000
  s_mov_b32 s55, 0x00020000
  s_cmp_eq_u32 s6, 0
  s_cbranch_scc0 h_h
  s_cmp_lt_u32 s5, 4
  s_cselect_b32 s48, s22, s24
  s_cselect_b32 s49, s23, s25
  s_and_b32 s49, s49, 0xffff
  s_mov_b32 s50, 0x80000
  s_mov_b32 s51, 0x00020000
  s_and_b32 s10, s5, 3
  s_lshl_b32 s10, s10, 17
  s_add_u32 s75, s10, s11
hab_pro:
  s_add_u32 m0, s73, s76
  s_add_u32 s14, s75, s71
  s_add_u32 s15, s74, s71
  buffer_load_dwordx4 v16, s[48:51], s14 offen offset:0 lds
  buffer_load_dwordx4 v17, s[48:51], s14 offen offset:1024 lds
  buffer_load_dwordx4 v18, s[48:51], s14 offen offset:2048 lds
  buffer_load_dwordx4 v19, s[48:51], s14 offen offset:3072 lds
  s_add_u32 m0, m0, 16384
  s_add_u32 s73, s73, 32768
  buffer_load_dwordx4 v16, s[44:47], s15 offen offset:0 lds
  buffer_load_dwordx4 v17, s[44:47], s15 offen offset:1024 lds
  buffer_load_dwordx4 v18, s[44:47], s15 offen offset:2048 lds
  buffer_load_dwordx4 v19, s[44:47], s15 offen offset:3072 lds
  s_add_u32 s71, s71, 128
  s_and_b32 s71, s71, 1023
  s_and_b32 s73, s73, 0x1ffff
  s_cmp_lg_u32 s73, 65536
  s_cbranch_scc1 hab_pro
  s_lshl_b32 s12, s5, 11
  s_lshl_b32 s13, s3, 9
  s_add_u32 s12, s12, s13
  s_add_u32 s79, s12, 0xf28000
  v_lshlrev_b32 v32, 4, v3
  s_lshl_b32 s10, s4, 11
  s_lshl_b32 s11, s3, 9
  s_add_u32 s10, s10, s11
  s_add_u32 s69, s10, 0xf20000
  s_cmp_lt_u32 s7, 2
  s_cselect_b32 s60, s18, s20
  s_cselect_b32 s61, s19, s21
  s_and_b32 s61, s61, 0xffff
  s_mov_b32 s62, 0x800000
  s_mov_b32 s63, 0x00020000
  s_lshr_b32 s10, s4, 3
  s_lshl_b32 s10, s10, 5
  s_add_u32 s10, s10, s77
  s_lshl_b32 s10, s10, 2
  s_add_u32 s10, s10, s3
  s_lshl_b32 s10, s10, 15
  s_and_b32 s11, s7, 1
  s_lshl_b32 s11, s11, 11
  s_add_u32 s72, s10, s11
  s_mov_b32 s70, 0
  v_and_b32 v129, 15, v1
  v_lshlrev_b32 v129, 7, v129
  v_bfe_u32 v6, v1, 4, 1
  v_lshl_add_u32 v129, v6, 12, v129
  s_setprio 3
  s_waitcnt vmcnt(8)
  s_barrier
hab_pro2:
  s_add_u32 m0, s73, s76
  s_add_u32 s14, s75, s71
  s_add_u32 s15, s74, s71
  buffer_load_dwordx4 v16, s[48:51], s14 offen offset:0 lds
  buffer_load_dwordx4 v17, s[48:51], s14 offen offset:1024 lds
  buffer_load_dwordx4 v18, s[48:51], s14 offen offset:2048 lds
  buffer_load_dwordx4 v19, s[48:51], s14 offen offset:3072 lds
  s_add_u32 m0, m0, 16384
  s_add_u32 s73, s73, 32768
  buffer_load_dwordx4 v16, s[44:47], s15 offen offset:0 lds
  buffer_load_dwordx4 v17, s[44:47], s15 offen offset:1024 lds
  buffer_load_dwordx4 v18, s[44:47], s15 offen offset:2048 lds
  buffer_load_dwordx4 v19, s[44:47], s15 offen offset:3072 lds
  s_add_u32 s71, s71, 128
  s_and_b32 s71, s71, 1023
  s_and_b32 s73, s73, 0x1ffff
  s_cmp_lg_u32 s73, 0
  s_cbranch_scc1 hab_pro2
  s_mov_b32 exec_hi, 0
  buffer_load_dword v255, v129, s[60:63], s72 offen
  s_mov_b32 exec_hi, -1
  s_mov_b32 s70, 8192
  s_waitcnt vmcnt(16)
hab_top:
  s_barrier
  s_add_u32 m0, s73, s76
  s_add_u32 s14, s75, s71
  s_add_u32 s15, s74, s71
  buffer_load_dwordx4 v16, s[48:51], s14 offen offset:0 lds
  buffer_load_dwordx4 v17, s[48:51], s14 offen offset:1024 lds
  buffer_load_dwordx4 v18, s[48:51], s14 offen offset:2048 lds
  buffer_load_dwordx4 v19, s[48:51], s14 offen offset:3072 lds
  s_add_u32 m0, m0, 16384
  s_add_u32 s73, s73, 32768
  buffer_load_dwordx4 v16, s[44:47], s15 offen offset:0 lds
  buffer_load_dwordx4 v17, s[44:47], s15 offen offset:1024 lds
  buffer_load_dwordx4 v18, s[44:47], s15 offen offset:2048 lds
  buffer_load_dwordx4 v19, s[44:47], s15 offen offset:3072 lds
  s_add_u32 s71, s71, 128
  s_and_b32 s71, s71, 1023
  s_and_b32 s73, s73, 0x1ffff
  s_add_u32 s10, s72, s70
  s_mov_b32 exec_hi, 0
  buffer_load_dword v255, v129, s[60:63], s10 offen
  s_mov_b32 exec_hi, -1
  s_add_u32 s70, s70, 8192
  s_and_b32 s70, s70, 0x7fff
  s_add_u32 s68, s68, 1
  s_waitcnt vmcnt(17)
  s_cmp_le_u32 s68, 4
  s_cbranch_scc1 hab_top
  s_barrier
  buffer_load_dwordx4 v[72:75], v32, s[52:55], s69 offen sc1
  buffer_load_dwordx4 v[68:71], v32, s[52:55], s79 offen sc1
  v_mov_b32 v251, 141344
  ds_read_b32 v250, v251
  s_waitcnt lgkmcnt(0)
  v_readfirstlane_b32 s42, v250
  s_lshl_b32 s10, s3, 9
  s_add_u32 s10, s10, 137216
  v_add_u32 v34, s10, v32
  v_lshrrev_b32 v6, 3, v1
  v_lshlrev_b32 v6, 12, v6
  v_lshrrev_b32 v7, 4, v1
  v_and_b32 v9, 7, v1
  v_xor_b32 v7, v7, v9
  v_lshl_add_u32 v16, v7, 4, v6
  v_xor_b32 v17, 64, v16
  v_add_u32 v17, 31744, v17
  v_add_u32 v18, 63488, v16
  v_add_u32 v19, 63488, v17
  s_cmp_lt_u32 s7, 2
  s_cselect_b32 s60, s18, s20
  s_cselect_b32 s61, s19, s21
  s_and_b32 s61, s61, 0xffff
  s_mov_b32 s62, 0x800000
  s_mov_b32 s63, 0x00020000
  s_lshl_b32 s10, s4, 19
  s_lshl_b32 s11, s3, 17
  s_add_u32 s10, s10, s11
  s_and_b32 s11, s7, 1
  s_lshl_b32 s11, s11, 11
  s_add_u32 s74, s10, s11
  s_lshl_b32 s10, s8, 2
  s_add_u32 s10, s10, s7
  s_lshl_b32 s10, s10, 18
  s_add_u32 s75, s10, s76
  s_add_u32 s71, s8, s4
  s_and_b32 s71, s71, 1
  s_and_b32 s71, s71, 15
  s_lshl_b32 s43, s71, 14
  s_lshl_b32 s71, s71, 7
  v_mov_b32 v21, s42
  v_mov_b32 v20, 0xf11000
  v_mov_b32 v25, 0xf11000
  s_waitcnt vmcnt(10)
  s_barrier
  s_waitcnt vmcnt(2)
  s_barrier
  s_mov_b32 s68, 0
hab_chk:
  s_waitcnt vmcnt(0)
  v_xor_b32 v6, s42, v75
  v_xor_b32 v7, s42, v71
  v_or_b32 v6, v6, v7
  v_cmp_ne_u32 vcc, 0, v6
  s_add_u32 s68, s68, 1
  s_nop 3
  s_cmp_eq_u64 vcc, 0
  s_cbranch_scc1 h_stats
  s_sleep 1
  buffer_load_dwordx4 v[72:75], v32, s[52:55], s69 offen sc1
  buffer_load_dwordx4 v[68:71], v32, s[52:55], s79 offen sc1
  s_cmp_lt_u32 s68, 200000
  s_cbranch_scc1 hab_chk
  s_branch h_stats
h_h:
  s_mov_b32 s48, s28
  s_and_b32 s49, s29, 0xffff
  s_mov_b32 s50, 0x1c0000
  s_mov_b32 s51, 0x00020000
  s_mul_i32 s75, s5, 448
  s_mov_b32 s10, 2341
  s_movk_i32 s11, 3584-28*16
  v_add_u32 v6, 0, v1
  v_mul_u32_u24 v7, s10, v6
  v_lshrrev_b32 v7, 16, v7
  v_mul_u32_u24 v7, s11, v7
  v_lshl_add_u32 v20, v6, 4, v7
  v_add_u32 v6, 64, v1
  v_mul_u32_u24 v7, s10, v6
  v_lshrrev_b32 v7, 16, v7
  v_mul_u32_u24 v7, s11, v7
  v_lshl_add_u32 v21, v6, 4, v7
  v_subrev_u32 v21, 1024, v21
  v_add_u32 v6, 128, v1
  v_mul_u32_u24 v7, s10, v6
  v_lshrrev_b32 v7, 16, v7
  v_mul_u32_u24 v7, s11, v7
  v_lshl_add_u32 v22, v6, 4, v7
  v_subrev_u32 v22, 2048, v22
  v_add_u32 v6, 192, v1
  v_mul_u32_u24 v7, s10, v6
  v_lshrrev_b32 v7, 16, v7
  v_mul_u32_u24 v7, s11, v7
  v_lshl_add_u32 v23, v6, 4, v7
  v_subrev_u32 v23, 3072, v23
  v_add_u32 v6, 256, v1
  v_mul_u32_u24 v7, s10, v6
  v_lshrrev_b32 v7, 16, v7
  v_mul_u32_u24 v7, s11, v7
  v_lshl_add_u32 v24, v6, 4, v7
  v_add_u32 v6, 320, v1
  v_mul_u32_u24 v7, s10, v6
  v_lshrrev_b32 v7, 16, v7
  v_mul_u32_u24 v7, s11, v7
  v_lshl_add_u32 v25, v6, 4, v7
  v_subrev_u32 v25, 1024, v25
  v_add_u32 v6, 384, v1
  v_mul_u32_u24 v7, s10, v6
  v_lshrrev_b32 v7, 16, v7
  v_mul_u32_u24 v7, s11, v7
  v_lshl_add_u32 v26, v6, 4, v7
  v_subrev_u32 v26, 2048, v26
  s_mul_i32 s10, s3, 57344
  s_add_u32 s75, s75, s10
  s_mul_i32 s79, s3, 7168
  s_add_u32 s79, s79, 16384
hh_pro:
  s_add_u32 m0, s73, s76
  s_add_u32 s15, s74, s71
  s_mul_i32 s14, s71, 1792
  buffer_load_dwordx4 v16, s[44:47], s15 offen offset:0 lds
  buffer_load_dwordx4 v17, s[44:47], s15 offen offset:1024 lds
  buffer_load_dwordx4 v18, s[44:47], s15 offen offset:2048 lds
  buffer_load_dwordx4 v19, s[44:47], s15 offen offset:3072 lds
  s_add_u32 m0, s73, s79
  s_add_u32 s14, s14, s75
  buffer_load_dwordx4 v20, s[48:51], s14 offen offset:0 lds
  buffer_load_dwordx4 v21, s[48:51], s14 offen offset:1024 lds
  buffer_load_dwordx4 v22, s[48:51], s14 offen offset:2048 lds
  buffer_load_dwordx4 v23, s[48:51], s14 offen offset:3072 lds
  s_add_u32 m0, m0, 4096
  s_add_u32 s73, s73, 45056
  buffer_load_dwordx4 v24, s[48:51], s14 offen offset:0 lds
  buffer_load_dwordx4 v25, s[48:51], s14 offen offset:1024 lds
  buffer_load_dwordx4 v26, s[48:51], s14 offen offset:2048 lds
  s_add_u32 s71, s71, 128
  s_and_b32 s71, s71, 1023
  s_cmp_eq_u32 s73, 135168
  s_cselect_b32 s73, 0, s73
  s_cmp_lg_u32 s73, 90112
  s_cbranch_scc1 hh_pro
  s_lshl_b32 s10, s3, 5
  v_lshl_add_u32 v6, v4, 7, v3
  v_add_u32 v6, s10, v6
  v_min_u32 v7, 223, v6
  v_lshlrev_b32 v33, 3, v7
  v_lshlrev_b32 v35, 1, v7
  v_lshl_add_u32 v34, v6, 4, 0
  v_add_u32 v34, 137216, v34
  v_lshlrev_b32 v32, 4, v3
  s_lshl_b32 s10, s4, 11
  s_lshl_b32 s11, s3, 9
  s_add_u32 s10, s10, s11
  s_add_u32 s69, s10, 0xf20000
  s_cmp_lt_u32 s7, 2
  s_cselect_b32 s60, s18, s20
  s_cselect_b32 s61, s19, s21
  s_and_b32 s61, s61, 0xffff
  s_mov_b32 s62, 0x800000
  s_mov_b32 s63, 0x00020000
  s_lshr_b32 s10, s4, 3
  s_lshl_b32 s10, s10, 5
  s_add_u32 s10, s10, s77
  s_lshl_b32 s10, s10, 2
  s_add_u32 s10, s10, s3
  s_lshl_b32 s10, s10, 15
  s_and_b32 s11, s7, 1
  s_lshl_b32 s11, s11, 11
  s_add_u32 s72, s10, s11
  s_mov_b32 s70, 0
  v_and_b32 v129, 15, v1
  v_lshlrev_b32 v129, 7, v129
  v_bfe_u32 v6, v1, 4, 1
  v_lshl_add_u32 v129, v6, 12, v129
  s_setprio 3
  s_waitcnt vmcnt(11)
  s_barrier
hh_pro2:
  s_add_u32 m0, s73, s76
  s_add_u32 s15, s74, s71
  s_mul_i32 s14, s71, 1792
  buffer_load_dwordx4 v16, s[44:47], s15 offen offset:0 lds
  buffer_load_dwordx4 v17, s[44:47], s15 offen offset:1024 lds
  buffer_load_dwordx4 v18, s[44:47], s15 offen offset:2048 lds
  buffer_load_dwordx4 v19, s[44:47], s15 offen offset:3072 lds
  s_add_u32 m0, s73, s79
  s_add_u32 s14, s14, s75
  buffer_load_dwordx4 v20, s[48:51], s14 offen offset:0 lds
  buffer_load_dwordx4 v21, s[48:51], s14 offen offset:1024 lds
  buffer_load_dwordx4 v22, s[48:51], s14 offen offset:2048 lds
  buffer_load_dwordx4 v23, s[48:51], s14 offen offset:3072 lds
  s_add_u32 m0, m0, 4096
  s_add_u32 s73, s73, 45056
  buffer_load_dwordx4 v24, s[48:51], s14 offen offset:0 lds
  buffer_load_dwordx4 v25, s[48:51], s14 offen offset:1024 lds
  buffer_load_dwordx4 v26, s[48:51], s14 offen offset:2048 lds
  s_add_u32 s71, s71, 128
  s_and_b32 s71, s71, 1023
  s_cmp_eq_u32 s73, 135168
  s_cselect_b32 s73, 0, s73
  s_cmp_lg_u32 s73, 0
  s_cbranch_scc1 hh_pro2
  s_mov_b32 exec_hi, 0
  buffer_load_dword v255, v129, s[60:63], s72 offen
  s_mov_b32 exec_hi, -1
  s_mov_b32 s70, 8192
  s_waitcnt vmcnt(11)
hh_top:
  s_barrier
  s_add_u32 m0, s73, s76
  s_add_u32 s15, s74, s71
  s_mul_i32 s14, s71, 1792
  buffer_load_dwordx4 v16, s[44:47], s15 offen offset:0 lds
  buffer_load_dwordx4 v17, s[44:47], s15 offen offset:1024 lds
  buffer_load_dwordx4 v18, s[44:47], s15 offen offset:2048 lds
  buffer_load_dwordx4 v19, s[44:47], s15 offen offset:3072 lds
  s_add_u32 m0, s73, s79
  s_add_u32 s14, s14, s75
  buffer_load_dwordx4 v20, s[48:51], s14 offen offset:0 lds
  buffer_load_dwordx4 v21, s[48:51], s14 offen offset:1024 lds
  buffer_load_dwordx4 v22, s[48:51], s14 offen offset:2048 lds
  buffer_load_dwordx4 v23, s[48:51], s14 offen offset:3072 lds
  s_add_u32 m0, m0, 4096
  s_add_u32 s73, s73, 45056
  buffer_load_dwordx4 v24, s[48:51], s14 offen offset:0 lds
  buffer_load_dwordx4 v25, s[48:51], s14 offen offset:1024 lds
  buffer_load_dwordx4 v26, s[48:51], s14 offen offset:2048 lds
  s_add_u32 s71, s71, 128
  s_and_b32 s71, s71, 1023
  s_cmp_eq_u32 s73, 135168
  s_cselect_b32 s73, 0, s73
  s_add_u32 s10, s72, s70
  s_mov_b32 exec_hi, 0
  buffer_load_dword v255, v129, s[60:63], s10 offen
  s_mov_b32 exec_hi, -1
  s_add_u32 s70, s70, 8192
  s_and_b32 s70, s70, 0x7fff
  s_add_u32 s68, s68, 1
  s_waitcnt vmcnt(12)
  s_cmp_le_u32 s68, 5
  s_cbranch_scc1 hh_top
  s_barrier
  buffer_load_dwordx4 v[72:75], v32, s[52:55], s69 offen sc1
  s_mul_i32 s10, s5, 28672
  s_add_u32 s10, s10, 0xf30000
  buffer_load_dwordx2 v[80:81], v33, s[52:55], s10 offen offset:0 sc1
  buffer_load_dwordx2 v[82:83], v33, s[52:55], s10 offen offset:1792 sc1
  s_add_u32 s10, s10, 3584
  buffer_load_dwordx2 v[84:85], v33, s[52:55], s10 offen offset:0 sc1
  buffer_load_dwordx2 v[86:87], v33, s[52:55], s10 offen offset:1792 sc1
  s_add_u32 s10, s10, 3584
  buffer_load_dwordx2 v[88:89], v33, s[52:55], s10 offen offset:0 sc1
  buffer_load_dwordx2 v[90:91], v33, s[52:55], s10 offen offset:1792 sc1
  s_add_u32 s10, s10, 3584
  buffer_load_dwordx2 v[92:93], v33, s[52:55], s10 offen offset:0 sc1
  buffer_load_dwordx2 v[94:95], v33, s[52:55], s10 offen offset:1792 sc1
  s_add_u32 s10, s10, 3584
  buffer_load_dwordx2 v[96:97], v33, s[52:55], s10 offen offset:0 sc1
  buffer_load_dwordx2 v[98:99], v33, s[52:55], s10 offen offset:1792 sc1
  s_add_u32 s10, s10, 3584
  buffer_load_dwordx2 v[100:101], v33, s[52:55], s10 offen offset:0 sc1
  buffer_load_dwordx2 v[102:103], v33, s[52:55], s10 offen offset:1792 sc1
  s_add_u32 s10, s10, 3584
  buffer_load_dwordx2 v[104:105], v33, s[52:55], s10 offen offset:0 sc1
  buffer_load_dwordx2 v[106:107], v33, s[52:55], s10 offen offset:1792 sc1
  s_add_u32 s10, s10, 3584
  buffer_load_dwordx2 v[108:109], v33, s[52:55], s10 offen offset:0 sc1
  buffer_load_dwordx2 v[110:111], v33, s[52:55], s10 offen offset:1792 sc1
  v_mov_b32 v251, 141344
  ds_read_b32 v250, v251
  s_waitcnt lgkmcnt(0)
  v_readfirstlane_b32 s42, v250
  s_mul_i32 s10, s5, 448
  s_mov_b32 s56, s30
  s_and_b32 s57, s31, 0xffff
  s_mov_b32 s58, 0xe00
  s_mov_b32 s59, 0x00020000
  buffer_load_ushort v53, v35, s[56:59], s10 offen
  v_lshrrev_b32 v6, 3, v1
  v_lshlrev_b32 v6, 12, v6
  v_lshrrev_b32 v7, 4, v1
  v_and_b32 v9, 7, v1
  v_xor_b32 v7, v7, v9
  v_lshl_add_u32 v16, v7, 4, v6
  v_xor_b32 v17, 64, v16
  v_add_u32 v17, 31744, v17
  v_add_u32 v18, 63488, v16
  v_add_u32 v19, 63488, v17
  s_cmp_lt_u32 s7, 2
  s_cselect_b32 s60, s18, s20
  s_cselect_b32 s61, s19, s21
  s_and_b32 s61, s61, 0xffff
  s_mov_b32 s62, 0x800000
  s_mov_b32 s63, 0x00020000
  s_lshl_b32 s10, s4, 19
  s_lshl_b32 s11, s3, 17
  s_add_u32 s10, s10, s11
  s_and_b32 s11, s7, 1
  s_lshl_b32 s11, s11, 11
  s_add_u32 s74, s10, s11
  s_lshl_b32 s10, s8, 2
  s_add_u32 s10, s10, s7
  s_lshl_b32 s10, s10, 18
  s_add_u32 s75, s10, s76
  s_add_u32 s71, s8, s4
  s_and_b32 s71, s71, 1
  s_and_b32 s71, s71, 15
  s_lshl_b32 s43, s71, 14
  s_lshl_b32 s71, s71, 7
  v_mov_b32 v21, s42
  v_mov_b32 v20, 0xf11000
  v_mov_b32 v25, 0xf11000
  s_waitcnt vmcnt(18)
  s_barrier
  s_mov_b32 s68, 0
hh_chk:
  s_waitcnt vmcnt(0)
  v_xor_b32 v6, s42, v75
  v_xor_b32 v7, s42, v81
  v_xor_b32 v8, s42, v83
  v_or3_b32 v6, v6, v7, v8
  v_xor_b32 v7, s42, v85
  v_xor_b32 v8, s42, v87
  v_or3_b32 v6, v6, v7, v8
  v_xor_b32 v7, s42, v89
  v_xor_b32 v8, s42, v91
  v_or3_b32 v6, v6, v7, v8
  v_xor_b32 v7, s42, v93
  v_xor_b32 v8, s42, v95
  v_or3_b32 v6, v6, v7, v8
  v_xor_b32 v7, s42, v97
  v_xor_b32 v8, s42, v99
  v_or3_b32 v6, v6, v7, v8
  v_xor_b32 v7, s42, v101
  v_xor_b32 v8, s42, v103
  v_or3_b32 v6, v6, v7, v8
  v_xor_b32 v7, s42, v105
  v_xor_b32 v8, s42, v107
  v_or3_b32 v6, v6, v7, v8
  v_xor_b32 v7, s42, v109
  v_xor_b32 v8, s42, v111
  v_or3_b32 v6, v6, v7, v8
  v_cmp_ne_u32 vcc, 0, v6
  s_add_u32 s68, s68, 1
  s_nop 3
  s_cmp_eq_u64 vcc, 0
  s_cbranch_scc1 hh_ok
  s_sleep 1
  buffer_load_dwordx4 v[72:75], v32, s[52:55], s69 offen sc1
  s_mul_i32 s10, s5, 28672
  s_add_u32 s10, s10, 0xf30000
  buffer_load_dwordx2 v[80:81], v33, s[52:55], s10 offen offset:0 sc1
  buffer_load_dwordx2 v[82:83], v33, s[52:55], s10 offen offset:1792 sc1
  s_add_u32 s10, s10, 3584
  buffer_load_dwordx2 v[84:85], v33, s[52:55], s10 offen offset:0 sc1
  buffer_load_dwordx2 v[86:87], v33, s[52:55], s10 offen offset:1792 sc1
  s_add_u32 s10, s10, 3584
  buffer_load_dwordx2 v[88:89], v33, s[52:55], s10 offen offset:0 sc1
  buffer_load_dwordx2 v[90:91], v33, s[52:55], s10 offen offset:1792 sc1
  s_add_u32 s10, s10, 3584
  buffer_load_dwordx2 v[92:93], v33, s[52:55], s10 offen offset:0 sc1
  buffer_load_dwordx2 v[94:95], v33, s[52:55], s10 offen offset:1792 sc1
  s_add_u32 s10, s10, 3584
  buffer_load_dwordx2 v[96:97], v33, s[52:55], s10 offen offset:0 sc1
  buffer_load_dwordx2 v[98:99], v33, s[52:55], s10 offen offset:1792 sc1
  s_add_u32 s10, s10, 3584
  buffer_load_dwordx2 v[100:101], v33, s[52:55], s10 offen offset:0 sc1
  buffer_load_dwordx2 v[102:103], v33, s[52:55], s10 offen offset:1792 sc1
  s_add_u32 s10, s10, 3584
  buffer_load_dwordx2 v[104:105], v33, s[52:55], s10 offen offset:0 sc1
  buffer_load_dwordx2 v[106:107], v33, s[52:55], s10 offen offset:1792 sc1
  s_add_u32 s10, s10, 3584
  buffer_load_dwordx2 v[108:109], v33, s[52:55], s10 offen offset:0 sc1
  buffer_load_dwordx2 v[110:111], v33, s[52:55], s10 offen offset:1792 sc1
  s_cmp_lt_u32 s68, 200000
  s_cbranch_scc1 hh_chk
  s_waitcnt vmcnt(0)
hh_ok:
  v_add_f32 v80, v80, v96
  v_add_f32 v82, v82, v98
  v_add_f32 v84, v84, v100
  v_add_f32 v86, v86, v102
  v_add_f32 v88, v88, v104
  v_add_f32 v90, v90, v106
  v_add_f32 v92, v92, v108
  v_add_f32 v94, v94, v110
  v_add_f32 v80, v80, v88
  v_add_f32 v82, v82, v90
  v_add_f32 v84, v84, v92
  v_add_f32 v86, v86, v94
  v_add_f32 v80, v80, v84
  v_add_f32 v82, v82, v86
  v_add_f32 v80, v80, v82
  v_cvt_pk_bf16_f32 v64, v80, v80
  v_lshlrev_b32 v6, 16, v64
  v_sub_f32 v80, v80, v6
  v_cvt_pk_bf16_f32 v65, v80, v80
  v_lshlrev_b32 v6, 16, v65
  v_sub_f32 v80, v80, v6
  v_cvt_pk_bf16_f32 v66, v80, v80
  v_and_b32 v64, 0xffff, v64
  v_lshl_or_b32 v68, v65, 16, v64
  v_and_b32 v66, 0xffff, v66
  v_lshl_or_b32 v69, v53, 16, v66
h_stats:
  s_waitcnt vmcnt(0)
  v_mov_b32 v70, 0
  v_mov_b32 v71, 0
  v_mov_b32 v7, 141312
  s_lshl_b32 s10, s3, 9
  s_add_u32 s10, s10, 135168
  v_add_u32 v6, s10, v32
  s_lshl_b32 s10, s3, 7
  s_add_u32 s10, s10, 141376
  v_lshl_add_u32 v10, v3, 2, s10
  ds_write_b64 v7, v[70:71]
  ds_write_b64 v7, v[70:71] offset:8
  ds_write_b64 v6, v[70:71] offset:8
  s_cmp_lt_u32 s5, 4
  s_cselect_b32 s10, 0, 0x80000000
  v_lshlrev_b32 v22, 2, v1
  s_waitcnt vmcnt(0)
  ds_write_b128 v34, v[68:71]
  ds_write_b64 v6, v[72:73]
  ds_write_b32 v10, v74
  v_xor_b32 v75, s10, v74
  ds_write_b32 v10, v75 offset:512
  s_waitcnt lgkmcnt(0)
  s_barrier
  s_mov_b32 s73, 0
hp_apro:
  s_add_u32 m0, s73, s76
  s_add_u32 s15, s74, s71
  buffer_load_dwordx4 v16, s[60:63], s15 offen offset:0 lds
  buffer_load_dwordx4 v17, s[60:63], s15 offen offset:1024 lds
  buffer_load_dwordx4 v18, s[60:63], s15 offen offset:2048 lds
  buffer_load_dwordx4 v19, s[60:63], s15 offen offset:3072 lds
  s_add_u32 s71, s71, 128
  s_and_b32 s71, s71, 2047
  s_add_u32 s73, s73, 32768
  s_cmp_lt_u32 s73, 131072
  s_cbranch_scc1 hp_apro
  s_cmp_eq_u32 s3, 0
  s_cbranch_scc1 hp_w4
  s_barrier
  s_branch hp_nopoll
hp_w4:
  s_lshl_b32 s10, s5, 1
  s_lshr_b32 s11, s4, 3
  s_add_u32 s10, s10, s11
  s_lshl_b32 s10, s10, 7
  s_and_b32 s11, s4, 7
  s_lshl_b32 s11, s11, 2
  s_add_u32 s10, s10, s11
  s_add_u32 s10, s10, 0xf10000
  s_lshl_b32 s11, s4, 7
  s_lshl_b32 s12, s5, 2
  s_add_u32 s11, s11, s12
  s_add_u32 s11, s11, 0xf11000
  s_lshl_b32 s12, s4, 3
  s_add_u32 s12, s12, s5
  s_min_u32 s12, s12, 111
  s_mul_i32 s13, s12, 2341
  s_lshr_b32 s13, s13, 16
  s_lshl_b32 s13, s13, 2
  s_add_u32 s12, s12, s13
  s_lshl_b32 s12, s12, 2
  s_add_u32 s12, s12, 0xf12000
  s_cmp_eq_u32 s6, 0
  s_cselect_b32 s14, s10, s11
  s_cselect_b32 s15, s12, s11
  v_mov_b32 v20, s14
  v_writelane_b32 v20, s15, 1
  s_lshl_b32 s10, s4, 7
  s_add_u32 s10, s10, 0xf11000
  s_mul_i32 s11, s8, 128
  s_add_u32 s11, s11, 0xf11fe0
  v_add_u32 v25, s10, v22
  v_add_u32 v26, s11, v22
  v_cmp_gt_u32 vcc, 8, v1
  s_lshr_b32 s10, s7, 1
  s_lshl_b32 s10, s10, 2
  v_cndmask_b32 v25, v26, v25, vcc
  s_add_u32 s10, s10, s8
  s_lshl_b32 s10, s10, 1
  s_and_b32 s11, s7, 1
  s_add_u32 s10, s10, s11
  s_lshl_b32 s10, s10, 7
  s_add_u32 s10, s10, 0xf10000
  s_mov_b32 s68, 0
  s_cmp_eq_u32 s6, 0
  s_cbranch_scc0 hp_zok
  s_barrier
  s_mov_b64 exec, 1
  buffer_store_dword v21, v20, s[52:55], 0 offen sc1
  s_mov_b64 exec, -1
hp_zok:
  s_mov_b64 exec, 0xff
  s_mov_b32 s68, 0
hp_poll:
  buffer_load_dword v24, v22, s[52:55], s10 offen sc1
  s_waitcnt vmcnt(0)
  v_cmp_ne_u32 vcc, s42, v24
  s_add_u32 s68, s68, 1
  s_nop 3
  s_cmp_eq_u64 vcc, 0
  s_cbranch_scc1 hp_pdone
  s_sleep 1
  s_cmp_lt_u32 s68, 200000
  s_cbranch_scc1 hp_poll
hp_pdone:
  s_mov_b64 exec, -1
  s_cmp_eq_u32 s6, 0
  s_cbranch_scc1 hp_nopoll
  s_barrier
hp_nopoll:
  s_barrier
  s_mov_b32 s72, 0
hp_bpro:
  s_add_u32 m0, s72, s76
  s_add_u32 m0, m0, 16384
  s_add_u32 s14, s75, s43
  buffer_load_dwordx4 v2, s[52:55], s14 offen offset:0 lds
  buffer_load_dwordx4 v2, s[52:55], s14 offen offset:1024 lds
  buffer_load_dwordx4 v2, s[52:55], s14 offen offset:2048 lds
  buffer_load_dwordx4 v2, s[52:55], s14 offen offset:3072 lds
  s_add_u32 s43, s43, 16384
  s_and_b32 s43, s43, 0x3ffff
  s_add_u32 s72, s72, 32768
  s_cmp_lt_u32 s72, 131072
  s_cbranch_scc1 hp_bpro
  s_lshr_b32 s10, s7, 1
  s_and_b32 s11, s7, 1
  s_mul_i32 s12, s4, 458752
  s_lshl_b32 s10, s10, 13
  s_add_u32 s12, s12, s10
  s_add_u32 s12, s12, 0x400000
  s_mul_i32 s13, s8, 458752
  s_lshl_b32 s11, s11, 13
  s_add_u32 s13, s13, s11
  s_add_u32 s13, s13, 0xc00000
  s_cmp_lt_u32 s3, 2
  s_cselect_b32 s69, s12, s13
  s_and_b32 s10, s3, 1
  s_lshl_b32 s10, s10, 14
  s_add_u32 s69, s69, s10
  v_add_u32 v128, 4096, v2
  s_lshl_b32 s70, s3, 13
  s_mov_b32 s68, 0
  s_waitcnt vmcnt(12)
hs_top:
  s_barrier
  s_cmp_eq_u32 s3, 0
  s_cbranch_scc1 hs_hook
hs_ret:
  s_add_u32 m0, s73, s76
  s_add_u32 s15, s74, s71
  buffer_load_dwordx4 v16, s[60:63], s15 offen offset:0 lds
  buffer_load_dwordx4 v17, s[60:63], s15 offen offset:1024 lds
  buffer_load_dwordx4 v18, s[60:63], s15 offen offset:2048 lds
  buffer_load_dwordx4 v19, s[60:63], s15 offen offset:3072 lds
  s_add_u32 s71, s71, 128
  s_and_b32 s71, s71, 2047
  s_add_u32 m0, s73, s76
  s_add_u32 m0, m0, 16384
  s_add_u32 s14, s75, s43
  buffer_load_dwordx4 v2, s[52:55], s14 offen offset:0 lds
  buffer_load_dwordx4 v2, s[52:55], s14 offen offset:1024 lds
  buffer_load_dwordx4 v2, s[52:55], s14 offen offset:2048 lds
  buffer_load_dwordx4 v2, s[52:55], s14 offen offset:3072 lds
  s_add_u32 s43, s43, 16384
  s_and_b32 s43, s43, 0x3ffff
  s_add_u32 s73, s73, 32768
  s_cmp_eq_u32 s73, 163840
  s_cselect_b32 s73, 0, s73
  s_add_u32 s68, s68, 1
  s_cmp_gt_u32 s68, 2
  s_cbranch_scc1 hs_w16
  s_waitcnt vmcnt(20)
  s_cmp_eq_u32 s68, 1
  s_cbranch_scc0 hs_w16
  s_waitcnt vmcnt(16)
hs_w16:
  s_waitcnt vmcnt(24)
  s_cmp_lt_u32 s68, 12
  s_cbranch_scc1 hs_top
  s_and_b32 s10, s4, 7
  s_lshl_b32 s11, s8, 1
  s_add_u32 s10, s10, s11
  s_mul_i32 s10, s10, 7
  s_lshr_b32 s10, s10, 2
  s_sub_u32 s11, s10, 14
  s_cmp_lt_u32 s10, 14
  s_cselect_b32 s10, s10, s11
  s_add_u32 s10, s8, s4
  s_and_b32 s10, s10, 1
  s_lshl_b32 s43, s10, 15
ho_top:
  s_barrier
  s_add_u32 m0, s73, s70
  s_add_u32 s14, s69, s43
  buffer_load_dwordx4 v2, s[52:55], s14 offen offset:0 lds
  buffer_load_dwordx4 v2, s[52:55], s14 offen offset:1024 lds
  buffer_load_dwordx4 v2, s[52:55], s14 offen offset:2048 lds
  buffer_load_dwordx4 v2, s[52:55], s14 offen offset:3072 lds
  s_add_u32 m0, m0, 4096
  s_add_u32 s73, s73, 32768
  buffer_load_dwordx4 v128, s[52:55], s14 offen offset:0 lds
  buffer_load_dwordx4 v128, s[52:55], s14 offen offset:1024 lds
  buffer_load_dwordx4 v128, s[52:55], s14 offen offset:2048 lds
  buffer_load_dwordx4 v128, s[52:55], s14 offen offset:3072 lds
  s_add_u32 s43, s43, 32768
  s_cmp_eq_u32 s43, 458752
  s_cselect_b32 s43, 0, s43
  s_cmp_eq_u32 s73, 163840
  s_cselect_b32 s73, 0, s73
  s_add_u32 s68, s68, 1
  s_waitcnt vmcnt(24)
  s_cmp_lt_u32 s68, 26
  s_cbranch_scc1 ho_top
  s_barrier
  s_waitcnt vmcnt(16)
  s_barrier
  s_waitcnt vmcnt(8)
  s_barrier
  s_waitcnt vmcnt(0)
  s_barrier
  s_endpgm
hs_hook:
  s_cmp_eq_u32 s68, 5
  s_cbranch_scc0 hs_h2
  s_mov_b64 exec, 2
  buffer_store_dword v21, v20, s[52:55], 0 offen sc1
  s_mov_b64 exec, -1
  s_branch hs_ret
hs_h2:
  s_cmp_eq_u32 s68, 10
  s_cbranch_scc0 hs_h3
  s_mov_b32 exec_hi, 15
  buffer_load_dword v24, v25, s[52:55], 0 offen sc1
  s_mov_b64 exec, -1
  s_branch hs_ret
hs_h3:
  s_cmp_eq_u32 s68, 11
  s_cbranch_scc0 hs_ret
  s_mov_b32 s12, 0
  s_mov_b32 exec_hi, 15
  s_waitcnt vmcnt(8)
hs_chk:
  v_cmp_ne_u32 vcc, s42, v24
  s_add_u32 s12, s12, 1
  s_nop 3
  s_cmp_eq_u64 vcc, 0
  s_cbranch_scc1 hs_cok
  s_sleep 1
  buffer_load_dword v24, v25, s[52:55], 0 offen sc1
  s_waitcnt vmcnt(0)
  s_cmp_lt_u32 s12, 200000
  s_cbranch_scc1 hs_chk
hs_cok:
  s_mov_b64 exec, -1
  s_branch hs_ret
k_end:
  s_endpgm
.section .rodata,"a"
.p2align 6
.amdhsa_kernel recurrent_scan__spectral_fnet__dense_activation_squared_relu__prompt_kernel
  .amdhsa_next_free_vgpr 256
  .amdhsa_next_free_sgpr 100
  .amdhsa_accum_offset 256
  .amdhsa_group_segment_fixed_size 0
  .amdhsa_kernarg_size 104
  .amdhsa_user_sgpr_count 2
  .amdhsa_user_sgpr_kernarg_segment_ptr 1
  .amdhsa_system_sgpr_workgroup_id_x 1
  .amdhsa_float_denorm_mode_32 3
  .amdhsa_float_denorm_mode_16_64 3
.end_amdhsa_kernel
```
